```python
import torch

def _softmax(x, axis=-1):
    return torch.softmax(x, dim=axis)
def _gelu(x):
    return torch.nn.functional.gelu(x, approximate="tanh")
def _silu(x):
    return torch.nn.functional.silu(x)
def _sigmoid(x):
    return torch.sigmoid(x)
def _layernorm(x, axis=-1, eps=1e-5):
    m = x.mean(dim=axis, keepdim=True)
    v = x.var(dim=axis, keepdim=True, unbiased=False)
    return (x - m) / torch.sqrt(v + eps)
def _scatter_add(tgt, idx, src, axis=0):
    return tgt.clone().index_add_(axis, idx, src)
def _segment_sum(src, seg, n):
    out = torch.zeros((n,) + src.shape[1:], dtype=src.dtype)
    return out.index_add_(0, seg, src)
def _pad(x, pw):
    flat = tuple(v for pair in reversed(pw) for v in pair)
    return torch.nn.functional.pad(x, flat)

kernel_name = 'standalone__detection_seg_fpn_lateral__vision'

def setup_inputs():

    _w = (lambda a: (lambda t: t.to(torch.bfloat16) if t.is_floating_point() else t)(torch.as_tensor(a)))
    H = W = (512 // 2) * 2
    C = 96
    k = 1
    return {
        "c_fine": _w((lambda *s: torch.randn(*s, dtype=torch.bfloat16) * 0.05)(1, H, W, C)),
        "p_coarse": _w((lambda *s: torch.randn(*s, dtype=torch.bfloat16) * 0.05)(1, H // 2, W // 2, C)),
        "w_lat": _w((lambda *s: torch.randn(*s, dtype=torch.bfloat16) * 0.05)(C, C)),
        "w_out": _w((lambda *s: torch.randn(*s, dtype=torch.bfloat16) * 0.05)(k, k, C, C)),
    }

def reference(c_fine, p_coarse, w_lat, w_out):
    B, H, W, C = c_fine.shape
    k = 1
    lat = torch.einsum("bhwc,cd->bhwd", c_fine, w_lat)
    up = (lambda x, n, axis: torch.repeat_interleave(x, n, dim=axis))((lambda x, n, axis: torch.repeat_interleave(x, n, dim=axis))(p_coarse, 2, axis=1), 2, axis=2)
    m = lat + up
    pad = k // 2
    mp = _pad(m, ((0, 0), (pad, pad), (pad, pad), (0, 0)))
    o = None
    for di in range(k):
        for dj in range(k):
            t = torch.einsum("bhwc,cd->bhwd", mp[:, di:di + H, dj:dj + W, :], w_out[di, dj])
            o = t if o is None else o + t
    return o
```

```asm
; @launch grid=(256,1,1) block=(256,1,1) lds=153600
.amdgcn_target "amdgcn-amd-amdhsa--gfx950"
.text
.globl standalone__detection_seg_fpn_lateral__vision_kernel
.p2align 8
.type standalone__detection_seg_fpn_lateral__vision_kernel,@function
standalone__detection_seg_fpn_lateral__vision_kernel:
    s_cmp_ge_u32 s2, 256
    s_cbranch_scc1 L_end
    s_load_dwordx4 s[8:11], s[0:1], 16
    s_load_dwordx2 s[20:21], s[0:1], 8
    s_load_dwordx2 s[16:17], s[0:1], 0
    s_load_dwordx2 s[28:29], s[0:1], 32
    s_load_dwordx2 s[92:93], s[0:1], 40
    s_memtime s[12:13]
    v_readfirstlane_b32 s14, v0
    v_and_b32 v0, 63, v0
    v_lshlrev_b32 v1, 4, v0
    s_lshr_b32 s14, s14, 6
    s_and_b32 s71, s2, 7
    s_lshl_b32 s15, s14, 3
    s_add_u32 s15, s15, s71
    s_mul_i32 s15, s15, 1536
    s_lshr_b32 s41, s2, 3
    s_mul_i32 s33, s14, 24576
    s_and_b32 s74, s14, 1
    s_mul_i32 s34, s74, 9216
    s_mul_i32 s35, s14, 9216
    s_add_u32 s35, s35, 116736
    s_mul_i32 s37, s41, 49152
    s_add_u32 s84, s37, s15
    s_add_u32 s3, s37, s84
    s_lshl_b32 s76, s3, 1
    s_add_u32 s3, s41, 5
    s_and_b32 s3, s3, 31
    s_add_u32 s3, s3, 32
    s_mul_i32 s37, s3, 49152
    s_add_u32 s85, s37, s15
    s_add_u32 s3, s37, s85
    s_lshl_b32 s77, s3, 1
    s_mov_b32 s18, 50331648
    s_mov_b32 s19, 0x20000
    s_mov_b32 s22, 12582912
    s_mov_b32 s23, 0x20000
    s_mov_b32 s26, 18432
    s_mov_b32 s27, 0x20000
    s_mov_b32 s30, 50331648
    s_mov_b32 s31, 0x20000
    s_mov_b32 s94, 244
    s_mov_b32 s95, 0x20000
    s_mov_b32 s75, 0
    v_xor_b32 v3, 32, v1
    v_and_b32 v7, 32, v0
    v_xor_b32 v2, v7, v1
    s_getreg_b32 s69, hwreg(HW_REG_XCC_ID, 0, 3)
    s_lshr_b32 s3, s71, 1
    s_xor_b32 s72, s3, s71
    s_and_b32 s72, s72, 1
    s_lshr_b32 s37, s69, 2
    s_xor_b32 s3, s3, s37
    s_and_b32 s3, s3, 1
    s_lshl_b32 s3, s3, 13
    s_and_b32 s37, s71, 3
    s_lshl_b32 s68, s41, 2
    s_or_b32 s68, s68, s37
    s_cmp_eq_u32 s41, 1
    s_cselect_b32 s37, 2, 0
    s_or_b32 s68, s68, s37
    s_lshl_b32 s68, s68, 21
    s_or_b32 s68, s68, s3
    s_mov_b32 m0, s35
    s_mov_b32 s36, s34
    s_sub_u32 s3, s41, 1
    s_cmp_lt_u32 s3, 5
    s_cbranch_scc1 L_prober
    s_cmp_lt_u32 s14, 2
    s_waitcnt lgkmcnt(0)
    s_cselect_b64 s[24:25], s[8:9], s[10:11]
    buffer_load_dwordx4 v1, s[24:27], s36 offen offset:0 lds
    s_add_u32 m0, s33, 15360
    s_nop 0
    buffer_load_dwordx4 v1, s[20:23], s84 offen nt lds
    s_mov_b32 exec_hi, 0
    buffer_load_dwordx4 v1, s[20:23], s84 offen offset:1024 nt lds
    s_mov_b32 exec_hi, -1
    s_add_u32 m0, s35, 0
    s_add_u32 s36, s34, 0
    buffer_load_dwordx4 v1, s[24:27], s36 offen offset:1024 lds
    buffer_load_dwordx4 v1, s[24:27], s36 offen offset:2048 lds
    s_add_u32 m0, s33, 16896
    s_nop 0
    buffer_load_dwordx4 v3, s[20:23], s85 offen nt lds
    s_add_u32 m0, s35, 0
    s_add_u32 s36, s34, 0
    buffer_load_dwordx4 v1, s[24:27], s36 offen offset:3072 lds
    s_add_u32 m0, s35, 4096
    s_add_u32 s36, s34, 4096
    buffer_load_dwordx4 v1, s[24:27], s36 offen offset:0 lds
    s_add_u32 m0, s33, 16896
    s_nop 0
    s_mov_b32 exec_hi, 0
    buffer_load_dwordx4 v3, s[20:23], s85 offen offset:1024 nt lds
    s_mov_b32 exec_hi, -1
    s_add_u32 m0, s33, 0
    s_nop 0
    buffer_load_dwordx4 v1, s[16:19], s76 offen offset:0 nt lds
    s_add_u32 m0, s35, 4096
    s_add_u32 s36, s34, 4096
    buffer_load_dwordx4 v1, s[24:27], s36 offen offset:1024 lds
    buffer_load_dwordx4 v1, s[24:27], s36 offen offset:2048 lds
    s_add_u32 m0, s33, 0
    s_nop 0
    buffer_load_dwordx4 v2, s[16:19], s76 offen offset:1024 nt lds
    s_add_u32 m0, s35, 4096
    s_add_u32 s36, s34, 4096
    buffer_load_dwordx4 v1, s[24:27], s36 offen offset:3072 lds
    s_add_u32 m0, s35, 8192
    s_add_u32 s36, s34, 8192
    buffer_load_dwordx4 v1, s[24:27], s36 offen offset:0 lds
    s_add_u32 m0, s33, 0
    s_nop 0
    buffer_load_dwordx4 v3, s[16:19], s76 offen offset:2048 nt lds
    s_add_u32 m0, s33, 3072
    s_add_u32 s43, s76, 98304
    buffer_load_dwordx4 v1, s[16:19], s43 offen offset:0 nt lds
    buffer_load_dwordx4 v2, s[16:19], s43 offen offset:1024 nt lds
    buffer_load_dwordx4 v3, s[16:19], s43 offen offset:2048 nt lds
    s_branch L_started
L_prober:
    s_mov_b32 s75, 1
    s_cmp_lt_u32 s14, 2
    s_waitcnt lgkmcnt(0)
    s_cselect_b64 s[24:25], s[8:9], s[10:11]
    s_cmp_lg_u32 s14, 0
    s_cbranch_scc1 L_pw
    s_mul_i32 s37, s12, 0x9e3779b1
    s_lshr_b32 s37, s37, 11
    s_and_b32 s37, s37, 0x1fdf80
    s_or_b32 s68, s68, s37
    s_mov_b64 exec, 1
    s_xor_b32 s37, s68, 8192
    buffer_load_dword v21, v0, s[16:19], s68 offen nt
    buffer_load_dword v21, v0, s[16:19], s37 offen nt
    s_mov_b64 exec, -1
L_pw:
    s_barrier
    buffer_load_dwordx4 v1, s[24:27], s36 offen offset:0 lds
    buffer_load_dwordx4 v1, s[24:27], s36 offen offset:1024 lds
    buffer_load_dwordx4 v1, s[24:27], s36 offen offset:2048 lds
    buffer_load_dwordx4 v1, s[24:27], s36 offen offset:3072 lds
    s_add_u32 m0, s35, 4096
    s_add_u32 s36, s34, 4096
    buffer_load_dwordx4 v1, s[24:27], s36 offen offset:0 lds
    buffer_load_dwordx4 v1, s[24:27], s36 offen offset:1024 lds
    buffer_load_dwordx4 v1, s[24:27], s36 offen offset:2048 lds
    buffer_load_dwordx4 v1, s[24:27], s36 offen offset:3072 lds
    s_add_u32 m0, s35, 8192
    s_add_u32 s36, s34, 8192
    buffer_load_dwordx4 v1, s[24:27], s36 offen offset:0 lds
    s_cmp_lg_u32 s14, 0
    s_cbranch_scc1 L_pd
    s_sub_u32 s69, s69, s2
    s_and_b32 s69, s69, 7
    s_lshl_b32 s69, s69, 1
    s_lshr_b32 s69, 0x55aa55, s69
    s_or_b32 s69, s69, 0xff00
    s_and_b32 s69, s69, 0xffff
    s_mul_i32 s70, s41, 48
    s_lshl_b32 s37, s71, 1
    s_add_u32 s72, s72, 1
    v_mov_b32 v20, 0
    v_mov_b32 v24, s69
    v_writelane_b32 v20, s70, 0
    s_waitcnt vmcnt(10)
    s_getreg_b32 s3, hwreg(HW_REG_IB_STS, 0, 4)
    s_cmp_eq_u32 s3, 10
    s_cselect_b32 s3, s72, 3
    s_lshl_b32 s3, s3, s37
    s_cmp_eq_u32 s2, 8
    v_writelane_b32 v24, s3, 0
    s_cselect_b64 exec, 3, 1
    buffer_atomic_or v24, v20, s[92:95], 0 offen sc1
    s_mov_b32 s75, 2
    s_mov_b64 exec, -1
L_pd:
    s_barrier
    s_add_u32 m0, s33, 15360
    s_nop 0
    buffer_load_dwordx4 v1, s[20:23], s84 offen nt lds
    s_mov_b32 exec_hi, 0
    buffer_load_dwordx4 v1, s[20:23], s84 offen offset:1024 nt lds
    s_mov_b32 exec_hi, -1
    s_add_u32 m0, s33, 16896
    s_nop 0
    buffer_load_dwordx4 v3, s[20:23], s85 offen nt lds
    s_mov_b32 exec_hi, 0
    buffer_load_dwordx4 v3, s[20:23], s85 offen offset:1024 nt lds
    s_mov_b32 exec_hi, -1
    s_add_u32 m0, s33, 0
    s_nop 0
    buffer_load_dwordx4 v1, s[16:19], s76 offen offset:0 nt lds
    buffer_load_dwordx4 v2, s[16:19], s76 offen offset:1024 nt lds
    buffer_load_dwordx4 v3, s[16:19], s76 offen offset:2048 nt lds
    s_add_u32 m0, s33, 3072
    s_add_u32 s43, s76, 98304
    buffer_load_dwordx4 v1, s[16:19], s43 offen offset:0 nt lds
    buffer_load_dwordx4 v2, s[16:19], s43 offen offset:1024 nt lds
    buffer_load_dwordx4 v3, s[16:19], s43 offen offset:2048 nt lds
L_started:
    v_and_b32 v18, 15, v0
    v_lshrrev_b32 v19, 4, v0
    v_lshrrev_b32 v15, 2, v18
    v_and_b32 v16, 3, v18
    v_lshl_add_u32 v11, v19, 3, v15
    v_mul_u32_u24 v11, 192, v11
    v_lshl_add_u32 v11, v16, 4, v11
    v_add_u32 v11, 135168, v11
    s_lshr_b32 s73, s14, 1
    s_lshl_b32 s3, s73, 3
    v_add_u32 v17, s3, v11
    s_mul_i32 s3, s74, 768
    s_add_u32 s3, s3, 116736
    v_lshl_add_u32 v12, v15, 3, v16
    v_mul_u32_u24 v12, 192, v12
    v_lshl_add_u32 v12, v19, 4, v12
    v_add_u32 v12, s3, v12
    v_add_u32 v14, 98304, v1
    s_mul_i32 s3, s73, 3072
    s_lshl_b32 s37, s74, 3
    s_add_u32 s3, s3, s37
    v_add_u32 v13, s3, v14
    v_mul_u32_u24 v15, 5, v0
    v_add_u32 v15, s41, v15
    v_and_b32 v15, 31, v15
    v_lshl_add_u32 v15, v0, 5, v15
    v_mul_u32_u24 v15, 6, v15
    v_add_u32 v15, 3, v15
    v_and_b32 v16, 64, v15
    v_lshrrev_b32 v15, 8, v15
    v_cmp_ne_u32 vcc, 0, v16
    v_mul_u32_u24 v20, 48, v15
    s_xor_b32 s3, s74, 1
    v_mov_b32 v22, s3
    s_bfe_i32 s3, s2, 0x10002
    s_xor_b32 s72, s3, vcc_lo
    s_not_b32 s70, s72
    s_and_b32 s71, s2, 3
    s_lshl_b32 s71, s71, 1
    s_add_u32 s71, s71, 1
    s_mov_b32 s68, 0x5555
    s_mov_b32 s69, 0
    v_lshrrev_b32 v15, 2, v18
    v_mul_u32_u24 v6, 192, v18
    v_and_b32 v16, 2, v15
    v_xor_b32 v16, v16, v19
    v_lshl_add_u32 v4, v16, 4, v6
    v_add_u32 v4, s33, v4
    v_lshrrev_b32 v15, 1, v18
    v_and_b32 v5, 6, v15
    v_and_or_b32 v5, v18, 1, v5
    v_and_b32 v16, 2, v18
    v_lshl_add_u32 v5, v16, 2, v5
    v_mul_u32_u24 v5, 192, v5
    v_xor_b32 v16, v16, v19
    v_lshl_add_u32 v5, v16, 4, v5
    v_add_u32 v5, s33, v5
    s_add_u32 s73, s33, 21504
    v_and_b32 v15, 3, v15
    v_xor_b32 v15, v15, v19
    v_lshl_add_u32 v6, v15, 4, v6
    v_add_u32 v6, s73, v6
    v_add_u32 v8, 0, v0
    v_mul_u32_u24 v16, 2731, v8
    v_bfe_u32 v16, v16, 16, 2
    v_xor_b32 v8, v8, v16
    v_lshl_add_u32 v8, v8, 4, s73
    v_add_u32 v9, 64, v0
    v_mul_u32_u24 v16, 2731, v9
    v_bfe_u32 v16, v16, 16, 2
    v_xor_b32 v9, v9, v16
    v_lshl_add_u32 v9, v9, 4, s73
    v_add_u32 v10, 128, v0
    v_mul_u32_u24 v16, 2731, v10
    v_bfe_u32 v16, v16, 16, 2
    v_xor_b32 v10, v10, v16
    v_lshl_add_u32 v10, v10, 4, s73
    s_and_b32 s13, s2, 3
    s_lshl_b32 s13, s13, 2
    s_add_u32 s13, s13, s14
    s_lshl_b32 s13, s13, 2
    s_mov_b32 s4, 0xf531a920
    s_mov_b32 s5, 0xed76cb84
    s_lshr_b64 s[4:5], s[4:5], s13
    s_bfe_u32 s12, s4, 0x10003
    s_mul_i32 s12, s12, 24576
    s_and_b32 s13, s4, 7
    s_lshl_b32 s3, s13, 2
    s_lshr_b32 s10, 0x88288588, s3
    s_and_b32 s10, s10, 15
    s_mul_i32 s10, s10, 12
    s_lshl_b32 s13, s13, 3
    s_mov_b32 s4, 0x2e100800
    s_mov_b32 s5, 0x635b3e36
    s_lshr_b64 s[4:5], s[4:5], s13
    s_and_b32 s4, s4, 0xff
    s_xor_b32 s5, s4, 64
    s_mul_i32 s6, s4, 192
    s_mul_i32 s7, s5, 192
    s_mov_b32 s4, 0x2e260800
    s_mov_b32 s5, 0x635b5336
    s_lshr_b64 s[4:5], s[4:5], s13
    s_and_b32 s4, s4, 0xff
    s_xor_b32 s5, s4, 64
    s_mul_i32 s8, s4, 192
    s_mul_i32 s9, s5, 192
    v_lshl_add_u32 v15, s6, 0, v1
    v_lshl_add_u32 v16, s7, 0, v1
    v_lshl_add_u32 v208, s8, 0, v1
    v_lshl_add_u32 v209, s9, 0, v1
    v_add_u32 v23, 0, v0
    v_cmp_le_u32 vcc, s10, v23
    s_nop 1
    v_cndmask_b32 v189, v15, v208, vcc
    v_cndmask_b32 v194, v16, v209, vcc
    v_add_u32 v23, 64, v0
    v_cmp_le_u32 vcc, s10, v23
    s_nop 1
    v_cndmask_b32 v190, v15, v208, vcc
    v_cndmask_b32 v195, v16, v209, vcc
    v_lshl_add_u32 v15, s6, 1, v1
    v_lshl_add_u32 v16, s7, 1, v1
    v_lshl_add_u32 v208, s8, 1, v1
    v_lshl_add_u32 v209, s9, 1, v1
    s_lshl_b32 s10, s10, 1
    v_add_u32 v23, 0, v0
    v_cmp_le_u32 vcc, s10, v23
    s_nop 1
    v_cndmask_b32 v186, v15, v208, vcc
    v_cndmask_b32 v191, v16, v209, vcc
    v_add_u32 v23, 64, v0
    v_cmp_le_u32 vcc, s10, v23
    s_nop 1
    v_cndmask_b32 v187, v15, v208, vcc
    v_cndmask_b32 v192, v16, v209, vcc
    v_add_u32 v23, 128, v0
    v_cmp_le_u32 vcc, s10, v23
    s_nop 1
    v_cndmask_b32 v188, v15, v208, vcc
    v_cndmask_b32 v193, v16, v209, vcc
    s_add_u32 s3, s41, 10
    s_and_b32 s3, s3, 31
    s_add_u32 s3, s3, 64
    s_mul_i32 s37, s3, 49152
    s_add_u32 s86, s37, s12
    s_add_u32 s3, s37, s86
    s_lshl_b32 s78, s3, 1
    s_add_u32 s3, s41, 15
    s_and_b32 s3, s3, 31
    s_add_u32 s3, s3, 96
    s_mul_i32 s37, s3, 49152
    s_add_u32 s87, s37, s12
    s_add_u32 s3, s37, s87
    s_lshl_b32 s79, s3, 1
    s_waitcnt vmcnt(11)
    s_cmp_eq_u32 s75, 2
    s_cbranch_scc1 L_wok
    s_waitcnt vmcnt(10)
    s_cmp_eq_u32 s75, 1
    s_cbranch_scc1 L_wok
    s_waitcnt vmcnt(4)
L_wok:
    s_barrier
    ds_read_b64_tr_b16 v[48:49], v17 offset:0
    ds_read_b64_tr_b16 v[50:51], v17 offset:768
    ds_read_b64_tr_b16 v[52:53], v17 offset:6144
    ds_read_b64_tr_b16 v[54:55], v17 offset:6912
    ds_read_b64_tr_b16 v[56:57], v17 offset:12288
    ds_read_b64_tr_b16 v[58:59], v17 offset:13056
    ds_read_b128 v[132:135], v12 offset:0
    ds_read_b128 v[136:139], v12 offset:64
    ds_read_b128 v[140:143], v12 offset:128
    ds_read_b128 v[144:147], v12 offset:6144
    ds_read_b128 v[148:151], v12 offset:6208
    ds_read_b128 v[152:155], v12 offset:6272
    ds_read_b128 v[156:159], v12 offset:12288
    ds_read_b128 v[160:163], v12 offset:12352
    ds_read_b128 v[164:167], v12 offset:12416
    s_add_u32 m0, s33, 6144
    s_nop 0
    buffer_load_dwordx4 v1, s[16:19], s77 offen offset:0 nt lds
    buffer_load_dwordx4 v2, s[16:19], s77 offen offset:1024 nt lds
    buffer_load_dwordx4 v3, s[16:19], s77 offen offset:2048 nt lds
    ds_read_b64_tr_b16 v[60:61], v17 offset:64
    ds_read_b64_tr_b16 v[62:63], v17 offset:832
    ds_read_b64_tr_b16 v[64:65], v17 offset:6208
    ds_read_b64_tr_b16 v[66:67], v17 offset:6976
    ds_read_b64_tr_b16 v[68:69], v17 offset:12352
    ds_read_b64_tr_b16 v[70:71], v17 offset:13120
    ds_read_b64_tr_b16 v[72:73], v17 offset:128
    ds_read_b64_tr_b16 v[74:75], v17 offset:896
    ds_read_b64_tr_b16 v[76:77], v17 offset:6272
    ds_read_b64_tr_b16 v[78:79], v17 offset:7040
    ds_read_b64_tr_b16 v[80:81], v17 offset:12416
    ds_read_b64_tr_b16 v[82:83], v17 offset:13184
    s_waitcnt lgkmcnt(14)
    v_mfma_f32_16x16x32_bf16 v[96:99], v[132:135], v[48:51], 0
    v_mfma_f32_16x16x32_bf16 v[96:99], v[136:139], v[52:55], v[96:99]
    v_mfma_f32_16x16x32_bf16 v[96:99], v[140:143], v[56:59], v[96:99]
    v_mfma_f32_16x16x32_bf16 v[100:103], v[144:147], v[48:51], 0
    v_mfma_f32_16x16x32_bf16 v[100:103], v[148:151], v[52:55], v[100:103]
    v_mfma_f32_16x16x32_bf16 v[100:103], v[152:155], v[56:59], v[100:103]
    s_waitcnt lgkmcnt(12)
    v_mfma_f32_16x16x32_bf16 v[104:107], v[156:159], v[48:51], 0
    v_mfma_f32_16x16x32_bf16 v[104:107], v[160:163], v[52:55], v[104:107]
    v_mfma_f32_16x16x32_bf16 v[104:107], v[164:167], v[56:59], v[104:107]
    s_waitcnt lgkmcnt(6)
    v_mfma_f32_16x16x32_bf16 v[108:111], v[132:135], v[60:63], 0
    ds_read_b64_tr_b16 a[72:73], v11 offset:0
    v_mfma_f32_16x16x32_bf16 v[108:111], v[136:139], v[64:67], v[108:111]
    ds_read_b64_tr_b16 a[74:75], v11 offset:768
    v_mfma_f32_16x16x32_bf16 v[108:111], v[140:143], v[68:71], v[108:111]
    ds_read_b64_tr_b16 a[76:77], v11 offset:6144
    v_cvt_pk_bf16_f32 v168, v96, v97
    v_cvt_pk_bf16_f32 v169, v98, v99
    ds_write_b64 v13, v[168:169] offset:0
    v_mfma_f32_16x16x32_bf16 v[112:115], v[144:147], v[60:63], 0
    ds_read_b64_tr_b16 a[78:79], v11 offset:6912
    v_mfma_f32_16x16x32_bf16 v[112:115], v[148:151], v[64:67], v[112:115]
    ds_read_b64_tr_b16 a[80:81], v11 offset:12288
    v_mfma_f32_16x16x32_bf16 v[112:115], v[152:155], v[68:71], v[112:115]
    ds_read_b64_tr_b16 a[82:83], v11 offset:13056
    v_cvt_pk_bf16_f32 v170, v100, v101
    v_cvt_pk_bf16_f32 v171, v102, v103
    ds_write_b64 v13, v[170:171] offset:1024
    v_mfma_f32_16x16x32_bf16 v[116:119], v[156:159], v[60:63], 0
    ds_read_b64_tr_b16 a[84:85], v11 offset:8
    v_mfma_f32_16x16x32_bf16 v[116:119], v[160:163], v[64:67], v[116:119]
    ds_read_b64_tr_b16 a[86:87], v11 offset:776
    v_mfma_f32_16x16x32_bf16 v[116:119], v[164:167], v[68:71], v[116:119]
    ds_read_b64_tr_b16 a[88:89], v11 offset:6152
    v_cvt_pk_bf16_f32 v172, v104, v105
    v_cvt_pk_bf16_f32 v173, v106, v107
    ds_write_b64 v13, v[172:173] offset:2048
    s_waitcnt lgkmcnt(12)
    v_mfma_f32_16x16x32_bf16 v[120:123], v[132:135], v[72:75], 0
    ds_read_b64_tr_b16 a[90:91], v11 offset:6920
    v_mfma_f32_16x16x32_bf16 v[120:123], v[136:139], v[76:79], v[120:123]
    ds_read_b64_tr_b16 a[92:93], v11 offset:12296
    v_mfma_f32_16x16x32_bf16 v[120:123], v[140:143], v[80:83], v[120:123]
    ds_read_b64_tr_b16 a[94:95], v11 offset:13064
    v_cvt_pk_bf16_f32 v174, v108, v109
    v_cvt_pk_bf16_f32 v175, v110, v111
    ds_write_b64 v13, v[174:175] offset:6144
    v_mfma_f32_16x16x32_bf16 v[124:127], v[144:147], v[72:75], 0
    ds_read_b64_tr_b16 a[96:97], v11 offset:64
    v_mfma_f32_16x16x32_bf16 v[124:127], v[148:151], v[76:79], v[124:127]
    ds_read_b64_tr_b16 a[98:99], v11 offset:832
    v_mfma_f32_16x16x32_bf16 v[124:127], v[152:155], v[80:83], v[124:127]
    ds_read_b64_tr_b16 a[100:101], v11 offset:6208
    v_cvt_pk_bf16_f32 v176, v112, v113
    v_cvt_pk_bf16_f32 v177, v114, v115
    ds_write_b64 v13, v[176:177] offset:7168
    v_mfma_f32_16x16x32_bf16 v[128:131], v[156:159], v[72:75], 0
    ds_read_b64_tr_b16 a[102:103], v11 offset:6976
    v_mfma_f32_16x16x32_bf16 v[128:131], v[160:163], v[76:79], v[128:131]
    ds_read_b64_tr_b16 a[104:105], v11 offset:12352
    v_mfma_f32_16x16x32_bf16 v[128:131], v[164:167], v[80:83], v[128:131]
    ds_read_b64_tr_b16 a[106:107], v11 offset:13120
    v_cvt_pk_bf16_f32 v178, v116, v117
    v_cvt_pk_bf16_f32 v179, v118, v119
    ds_write_b64 v13, v[178:179] offset:8192
    buffer_load_dword v21, v20, s[92:95], 0 offen sc1
    s_add_u32 m0, s33, 9216
    s_add_u32 s43, s77, 98304
    buffer_load_dwordx4 v1, s[16:19], s43 offen offset:0 nt lds
    buffer_load_dwordx4 v2, s[16:19], s43 offen offset:1024 nt lds
    buffer_load_dwordx4 v3, s[16:19], s43 offen offset:2048 nt lds
    ds_read_b64_tr_b16 a[108:109], v11 offset:72
    ds_read_b64_tr_b16 a[110:111], v11 offset:840
    ds_read_b64_tr_b16 a[112:113], v11 offset:6216
    ds_read_b64_tr_b16 a[114:115], v11 offset:6984
    ds_read_b64_tr_b16 a[116:117], v11 offset:12360
    ds_read_b64_tr_b16 a[118:119], v11 offset:13128
    v_cvt_pk_bf16_f32 v180, v120, v121
    v_cvt_pk_bf16_f32 v181, v122, v123
    ds_write_b64 v13, v[180:181] offset:12288
    v_cvt_pk_bf16_f32 v182, v124, v125
    v_cvt_pk_bf16_f32 v183, v126, v127
    ds_write_b64 v13, v[182:183] offset:13312
    v_cvt_pk_bf16_f32 v184, v128, v129
    v_cvt_pk_bf16_f32 v185, v130, v131
    ds_write_b64 v13, v[184:185] offset:14336
    s_waitcnt lgkmcnt(0)
    s_barrier
    ds_read_b64_tr_b16 a[120:121], v11 offset:128
    ds_read_b64_tr_b16 a[122:123], v11 offset:896
    ds_read_b64_tr_b16 a[124:125], v11 offset:6272
    ds_read_b64_tr_b16 a[126:127], v11 offset:7040
    ds_read_b64_tr_b16 a[128:129], v11 offset:12416
    ds_read_b64_tr_b16 a[130:131], v11 offset:13184
    ds_read_b64_tr_b16 a[132:133], v11 offset:136
    ds_read_b64_tr_b16 a[134:135], v11 offset:904
    ds_read_b64_tr_b16 a[136:137], v11 offset:6280
    ds_read_b64_tr_b16 a[138:139], v11 offset:7048
    ds_read_b64_tr_b16 a[140:141], v11 offset:12424
    ds_read_b64_tr_b16 a[142:143], v11 offset:13192
    s_waitcnt vmcnt(4)
    s_waitcnt vmcnt(3)
L_tab:
    v_lshrrev_b32 v15, 1, v21
    v_readfirstlane_b32 s37, v21
    v_or_b32 v16, v15, v21
    v_and_b32 v18, s68, v21
    v_and_b32 v16, s68, v16
    v_and_b32 v19, s68, v15
    v_cmp_ne_u32 s[4:5], s68, v16
    v_bcnt_u32_b32 v18, v18, v22
    v_bcnt_u32_b32 v19, v19, 0
    s_bitcmp1_b32 s37, s71
    v_cmp_ge_u32 vcc, v19, v18
    s_cselect_b32 s38, s70, s72
    s_and_b32 s3, s4, 0xfd
    s_cbranch_scc1 L_tab_slow
    s_xor_b32 s38, s38, vcc_lo
    s_bitcmp1_b32 s38, 2
    s_cselect_b64 vcc, -1, 0
    v_cndmask_b32 v202, v186, v191, vcc
    v_cndmask_b32 v203, v187, v192, vcc
    v_cndmask_b32 v204, v188, v193, vcc
    v_xor_b32 v208, v7, v203
    v_xor_b32 v209, 32, v204
    s_add_u32 m0, s33, 12288
    s_nop 0
    buffer_load_dwordx4 v202, s[16:19], s78 offen offset:0 nt lds
    buffer_load_dwordx4 v208, s[16:19], s78 offen offset:1024 nt lds
    buffer_load_dwordx4 v209, s[16:19], s78 offen offset:2048 nt lds
    s_bitcmp1_b32 s38, 2
    s_cselect_b64 vcc, -1, 0
    v_cndmask_b32 v210, v189, v194, vcc
    v_cndmask_b32 v211, v190, v195, vcc
    s_add_u32 m0, s33, 18432
    s_nop 0
    buffer_load_dwordx4 v210, s[20:23], s86 offen nt lds
    s_mov_b32 exec_hi, 0
    buffer_load_dwordx4 v211, s[20:23], s86 offen offset:1024 nt lds
    s_mov_b32 exec_hi, -1
    s_bitcmp1_b32 s38, 3
    s_cselect_b64 vcc, -1, 0
    v_cndmask_b32 v212, v189, v194, vcc
    v_xor_b32 v212, 32, v212
    v_cndmask_b32 v213, v190, v195, vcc
    v_xor_b32 v213, 32, v213
    s_add_u32 m0, s33, 19968
    s_nop 0
    buffer_load_dwordx4 v212, s[20:23], s87 offen nt lds
    s_mov_b32 exec_hi, 0
    buffer_load_dwordx4 v213, s[20:23], s87 offen offset:1024 nt lds
    s_mov_b32 exec_hi, -1
    ds_read_b128 v[36:39], v5 offset:15360
    ds_read_b128 v[40:43], v5 offset:15424
    ds_read_b128 v[44:47], v5 offset:15488
    ds_read_b128 v[24:27], v4 offset:0
    ds_read_b128 v[28:31], v4 offset:64
    ds_read_b128 v[32:35], v4 offset:128
    s_waitcnt lgkmcnt(3)
    v_mfma_f32_16x16x32_bf16 v[48:51], a[72:75], v[36:39], 0
    ds_read_b128 a[0:3], v14 offset:0
    ds_read_b128 a[4:7], v14 offset:1024
    v_mfma_f32_16x16x32_bf16 v[48:51], a[76:79], v[40:43], v[48:51]
    ds_read_b128 a[8:11], v14 offset:2048
    v_mfma_f32_16x16x32_bf16 v[48:51], a[80:83], v[44:47], v[48:51]
    ds_read_b128 a[12:15], v14 offset:3072
    ds_read_b128 a[16:19], v14 offset:4096
    v_mfma_f32_16x16x32_bf16 v[52:55], a[84:87], v[36:39], 0
    ds_read_b128 a[20:23], v14 offset:5120
    v_mfma_f32_16x16x32_bf16 v[52:55], a[88:91], v[40:43], v[52:55]
    ds_read_b128 a[24:27], v14 offset:6144
    ds_read_b128 a[28:31], v14 offset:7168
    v_mfma_f32_16x16x32_bf16 v[52:55], a[92:95], v[44:47], v[52:55]
    ds_read_b128 a[32:35], v14 offset:8192
    v_mfma_f32_16x16x32_bf16 v[56:59], a[96:99], v[36:39], 0
    ds_read_b128 a[36:39], v14 offset:9216
    ds_read_b128 a[40:43], v14 offset:10240
    v_mfma_f32_16x16x32_bf16 v[56:59], a[100:103], v[40:43], v[56:59]
    ds_read_b128 a[44:47], v14 offset:11264
    v_mfma_f32_16x16x32_bf16 v[56:59], a[104:107], v[44:47], v[56:59]
    ds_read_b128 a[48:51], v14 offset:12288
    ds_read_b128 a[52:55], v14 offset:13312
    v_mfma_f32_16x16x32_bf16 v[60:63], a[108:111], v[36:39], 0
    ds_read_b128 a[56:59], v14 offset:14336
    v_mfma_f32_16x16x32_bf16 v[60:63], a[112:115], v[40:43], v[60:63]
    ds_read_b128 a[60:63], v14 offset:15360
    ds_read_b128 a[64:67], v14 offset:16384
    v_mfma_f32_16x16x32_bf16 v[60:63], a[116:119], v[44:47], v[60:63]
    ds_read_b128 a[68:71], v14 offset:17408
    v_mov_b32_dpp v72, v48 quad_perm:[0,0,1,1] row_mask:0xf bank_mask:0xf
    v_mov_b32_dpp v73, v49 quad_perm:[0,0,1,1] row_mask:0xf bank_mask:0xf
    v_mfma_f32_16x16x32_bf16 v[64:67], a[120:123], v[36:39], 0
    v_mov_b32_dpp v74, v50 quad_perm:[0,0,1,1] row_mask:0xf bank_mask:0xf
    v_mov_b32_dpp v75, v51 quad_perm:[0,0,1,1] row_mask:0xf bank_mask:0xf
    v_mfma_f32_16x16x32_bf16 v[64:67], a[124:127], v[40:43], v[64:67]
    v_mov_b32_dpp v76, v52 quad_perm:[0,0,1,1] row_mask:0xf bank_mask:0xf
    v_mov_b32_dpp v77, v53 quad_perm:[0,0,1,1] row_mask:0xf bank_mask:0xf
    v_mfma_f32_16x16x32_bf16 v[64:67], a[128:131], v[44:47], v[64:67]
    v_mov_b32_dpp v78, v54 quad_perm:[0,0,1,1] row_mask:0xf bank_mask:0xf
    v_mov_b32_dpp v79, v55 quad_perm:[0,0,1,1] row_mask:0xf bank_mask:0xf
    v_mfma_f32_16x16x32_bf16 v[68:71], a[132:135], v[36:39], 0
    v_mov_b32_dpp v80, v56 quad_perm:[0,0,1,1] row_mask:0xf bank_mask:0xf
    v_mov_b32_dpp v81, v57 quad_perm:[0,0,1,1] row_mask:0xf bank_mask:0xf
    v_mfma_f32_16x16x32_bf16 v[68:71], a[136:139], v[40:43], v[68:71]
    v_mov_b32_dpp v82, v58 quad_perm:[0,0,1,1] row_mask:0xf bank_mask:0xf
    v_mov_b32_dpp v83, v59 quad_perm:[0,0,1,1] row_mask:0xf bank_mask:0xf
    v_mfma_f32_16x16x32_bf16 v[68:71], a[140:143], v[44:47], v[68:71]
    v_mov_b32_dpp v84, v60 quad_perm:[0,0,1,1] row_mask:0xf bank_mask:0xf
    v_mov_b32_dpp v85, v61 quad_perm:[0,0,1,1] row_mask:0xf bank_mask:0xf
    v_mov_b32_dpp v86, v62 quad_perm:[0,0,1,1] row_mask:0xf bank_mask:0xf
    v_mov_b32_dpp v87, v63 quad_perm:[0,0,1,1] row_mask:0xf bank_mask:0xf
    v_mov_b32_dpp v88, v64 quad_perm:[0,0,1,1] row_mask:0xf bank_mask:0xf
    v_mov_b32_dpp v89, v65 quad_perm:[0,0,1,1] row_mask:0xf bank_mask:0xf
    v_mov_b32_dpp v90, v66 quad_perm:[0,0,1,1] row_mask:0xf bank_mask:0xf
    v_mov_b32_dpp v91, v67 quad_perm:[0,0,1,1] row_mask:0xf bank_mask:0xf
    v_mov_b32_dpp v92, v68 quad_perm:[0,0,1,1] row_mask:0xf bank_mask:0xf
    v_mov_b32_dpp v93, v69 quad_perm:[0,0,1,1] row_mask:0xf bank_mask:0xf
    v_mov_b32_dpp v94, v70 quad_perm:[0,0,1,1] row_mask:0xf bank_mask:0xf
    v_mov_b32_dpp v95, v71 quad_perm:[0,0,1,1] row_mask:0xf bank_mask:0xf
    s_waitcnt lgkmcnt(0)
    v_mfma_f32_16x16x32_bf16 v[96:99], a[0:3], v[24:27], v[72:75]
    v_mfma_f32_16x16x32_bf16 v[96:99], a[4:7], v[28:31], v[96:99]
    v_mfma_f32_16x16x32_bf16 v[96:99], a[8:11], v[32:35], v[96:99]
    v_mfma_f32_16x16x32_bf16 v[100:103], a[12:15], v[24:27], v[76:79]
    v_mfma_f32_16x16x32_bf16 v[100:103], a[16:19], v[28:31], v[100:103]
    v_mfma_f32_16x16x32_bf16 v[100:103], a[20:23], v[32:35], v[100:103]
    v_mfma_f32_16x16x32_bf16 v[104:107], a[24:27], v[24:27], v[80:83]
    v_mfma_f32_16x16x32_bf16 v[104:107], a[28:31], v[28:31], v[104:107]
    v_mfma_f32_16x16x32_bf16 v[104:107], a[32:35], v[32:35], v[104:107]
    v_mfma_f32_16x16x32_bf16 v[108:111], a[36:39], v[24:27], v[84:87]
    v_mfma_f32_16x16x32_bf16 v[108:111], a[40:43], v[28:31], v[108:111]
    v_mfma_f32_16x16x32_bf16 v[108:111], a[44:47], v[32:35], v[108:111]
    v_mfma_f32_16x16x32_bf16 v[112:115], a[48:51], v[24:27], v[88:91]
    v_cvt_pk_bf16_f32 v120, v96, v97
    v_mfma_f32_16x16x32_bf16 v[112:115], a[52:55], v[28:31], v[112:115]
    v_cvt_pk_bf16_f32 v121, v98, v99
    v_mfma_f32_16x16x32_bf16 v[112:115], a[56:59], v[32:35], v[112:115]
    v_cvt_pk_bf16_f32 v122, v100, v101
    v_mfma_f32_16x16x32_bf16 v[116:119], a[60:63], v[24:27], v[92:95]
    v_cvt_pk_bf16_f32 v123, v102, v103
    v_mfma_f32_16x16x32_bf16 v[116:119], a[64:67], v[28:31], v[116:119]
    ds_write_b128 v6, v[120:123] offset:0
    v_mfma_f32_16x16x32_bf16 v[116:119], a[68:71], v[32:35], v[116:119]
    v_cvt_pk_bf16_f32 v124, v104, v105
    v_cvt_pk_bf16_f32 v125, v106, v107
    v_cvt_pk_bf16_f32 v126, v108, v109
    v_cvt_pk_bf16_f32 v127, v110, v111
    ds_write_b128 v6, v[124:127] offset:64
    s_nop 0
    v_cvt_pk_bf16_f32 v128, v112, v113
    v_cvt_pk_bf16_f32 v129, v114, v115
    v_cvt_pk_bf16_f32 v130, v116, v117
    v_cvt_pk_bf16_f32 v131, v118, v119
    ds_write_b128 v6, v[128:131] offset:128
    ds_read_b128 v[132:135], v8
    ds_read_b128 v[136:139], v9
    ds_read_b128 v[140:143], v10
    s_waitcnt lgkmcnt(2)
    buffer_store_dwordx4 v[132:135], v1, s[28:31], s76 offen offset:0 sc1
    s_waitcnt lgkmcnt(1)
    buffer_store_dwordx4 v[136:139], v1, s[28:31], s76 offen offset:1024 sc1
    s_waitcnt lgkmcnt(0)
    buffer_store_dwordx4 v[140:143], v1, s[28:31], s76 offen offset:2048 sc1
    ds_read_b128 v[24:27], v4 offset:3072
    ds_read_b128 v[28:31], v4 offset:3136
    ds_read_b128 v[32:35], v4 offset:3200
    s_add_u32 m0, s33, 0
    s_add_u32 s43, s78, 98304
    buffer_load_dwordx4 v202, s[16:19], s43 offen offset:0 nt lds
    buffer_load_dwordx4 v208, s[16:19], s43 offen offset:1024 nt lds
    buffer_load_dwordx4 v209, s[16:19], s43 offen offset:2048 nt lds
    s_add_u32 s3, s41, 20
    s_and_b32 s3, s3, 31
    s_add_u32 s3, s3, 128
    s_mul_i32 s37, s3, 49152
    s_add_u32 s88, s37, s12
    s_add_u32 s3, s37, s88
    s_lshl_b32 s80, s3, 1
    s_bitcmp1_b32 s38, 4
    s_cselect_b64 vcc, -1, 0
    v_cndmask_b32 v210, v189, v194, vcc
    v_cndmask_b32 v211, v190, v195, vcc
    s_add_u32 m0, s33, 15360
    s_nop 0
    buffer_load_dwordx4 v210, s[20:23], s88 offen nt lds
    s_waitcnt lgkmcnt(0)
    v_mfma_f32_16x16x32_bf16 v[96:99], a[0:3], v[24:27], v[72:75]
    v_mfma_f32_16x16x32_bf16 v[96:99], a[4:7], v[28:31], v[96:99]
    v_mfma_f32_16x16x32_bf16 v[96:99], a[8:11], v[32:35], v[96:99]
    v_mfma_f32_16x16x32_bf16 v[100:103], a[12:15], v[24:27], v[76:79]
    v_mfma_f32_16x16x32_bf16 v[100:103], a[16:19], v[28:31], v[100:103]
    v_mfma_f32_16x16x32_bf16 v[100:103], a[20:23], v[32:35], v[100:103]
    v_mfma_f32_16x16x32_bf16 v[104:107], a[24:27], v[24:27], v[80:83]
    v_mfma_f32_16x16x32_bf16 v[104:107], a[28:31], v[28:31], v[104:107]
    v_mfma_f32_16x16x32_bf16 v[104:107], a[32:35], v[32:35], v[104:107]
    v_mfma_f32_16x16x32_bf16 v[108:111], a[36:39], v[24:27], v[84:87]
    v_mfma_f32_16x16x32_bf16 v[108:111], a[40:43], v[28:31], v[108:111]
    v_mfma_f32_16x16x32_bf16 v[108:111], a[44:47], v[32:35], v[108:111]
    v_mfma_f32_16x16x32_bf16 v[112:115], a[48:51], v[24:27], v[88:91]
    v_cvt_pk_bf16_f32 v120, v96, v97
    v_mfma_f32_16x16x32_bf16 v[112:115], a[52:55], v[28:31], v[112:115]
    v_cvt_pk_bf16_f32 v121, v98, v99
    v_mfma_f32_16x16x32_bf16 v[112:115], a[56:59], v[32:35], v[112:115]
    v_cvt_pk_bf16_f32 v122, v100, v101
    v_mfma_f32_16x16x32_bf16 v[116:119], a[60:63], v[24:27], v[92:95]
    v_cvt_pk_bf16_f32 v123, v102, v103
    v_mfma_f32_16x16x32_bf16 v[116:119], a[64:67], v[28:31], v[116:119]
    ds_write_b128 v6, v[120:123] offset:0
    v_mfma_f32_16x16x32_bf16 v[116:119], a[68:71], v[32:35], v[116:119]
    v_cvt_pk_bf16_f32 v124, v104, v105
    v_cvt_pk_bf16_f32 v125, v106, v107
    v_cvt_pk_bf16_f32 v126, v108, v109
    v_cvt_pk_bf16_f32 v127, v110, v111
    ds_write_b128 v6, v[124:127] offset:64
    s_add_u32 s32, s76, 98304
    v_cvt_pk_bf16_f32 v128, v112, v113
    v_cvt_pk_bf16_f32 v129, v114, v115
    v_cvt_pk_bf16_f32 v130, v116, v117
    v_cvt_pk_bf16_f32 v131, v118, v119
    ds_write_b128 v6, v[128:131] offset:128
    ds_read_b128 v[132:135], v8
    ds_read_b128 v[136:139], v9
    ds_read_b128 v[140:143], v10
    s_waitcnt lgkmcnt(2)
    buffer_store_dwordx4 v[132:135], v1, s[28:31], s32 offen offset:0 sc1
    s_waitcnt lgkmcnt(1)
    buffer_store_dwordx4 v[136:139], v1, s[28:31], s32 offen offset:1024 sc1
    s_waitcnt lgkmcnt(0)
    buffer_store_dwordx4 v[140:143], v1, s[28:31], s32 offen offset:2048 sc1
    ds_read_b128 v[24:27], v4 offset:6144
    ds_read_b128 v[28:31], v4 offset:6208
    ds_read_b128 v[32:35], v4 offset:6272
    s_bitcmp1_b32 s38, 3
    s_cselect_b64 vcc, -1, 0
    v_cndmask_b32 v205, v186, v191, vcc
    v_cndmask_b32 v206, v187, v192, vcc
    v_cndmask_b32 v207, v188, v193, vcc
    v_xor_b32 v208, v7, v206
    v_xor_b32 v209, 32, v207
    s_add_u32 m0, s33, 3072
    s_nop 0
    buffer_load_dwordx4 v205, s[16:19], s79 offen offset:0 nt lds
    buffer_load_dwordx4 v208, s[16:19], s79 offen offset:1024 nt lds
    buffer_load_dwordx4 v209, s[16:19], s79 offen offset:2048 nt lds
    s_add_u32 m0, s33, 15360
    s_nop 0
    s_mov_b32 exec_hi, 0
    buffer_load_dwordx4 v211, s[20:23], s88 offen offset:1024 nt lds
    s_mov_b32 exec_hi, -1
    v_mov_b32_dpp v72, v48 quad_perm:[2,2,3,3] row_mask:0xf bank_mask:0xf
    v_mov_b32_dpp v73, v49 quad_perm:[2,2,3,3] row_mask:0xf bank_mask:0xf
    v_mov_b32_dpp v74, v50 quad_perm:[2,2,3,3] row_mask:0xf bank_mask:0xf
    v_mov_b32_dpp v75, v51 quad_perm:[2,2,3,3] row_mask:0xf bank_mask:0xf
    v_mov_b32_dpp v76, v52 quad_perm:[2,2,3,3] row_mask:0xf bank_mask:0xf
    v_mov_b32_dpp v77, v53 quad_perm:[2,2,3,3] row_mask:0xf bank_mask:0xf
    v_mov_b32_dpp v78, v54 quad_perm:[2,2,3,3] row_mask:0xf bank_mask:0xf
    v_mov_b32_dpp v79, v55 quad_perm:[2,2,3,3] row_mask:0xf bank_mask:0xf
    v_mov_b32_dpp v80, v56 quad_perm:[2,2,3,3] row_mask:0xf bank_mask:0xf
    v_mov_b32_dpp v81, v57 quad_perm:[2,2,3,3] row_mask:0xf bank_mask:0xf
    v_mov_b32_dpp v82, v58 quad_perm:[2,2,3,3] row_mask:0xf bank_mask:0xf
    v_mov_b32_dpp v83, v59 quad_perm:[2,2,3,3] row_mask:0xf bank_mask:0xf
    v_mov_b32_dpp v84, v60 quad_perm:[2,2,3,3] row_mask:0xf bank_mask:0xf
    v_mov_b32_dpp v85, v61 quad_perm:[2,2,3,3] row_mask:0xf bank_mask:0xf
    v_mov_b32_dpp v86, v62 quad_perm:[2,2,3,3] row_mask:0xf bank_mask:0xf
    v_mov_b32_dpp v87, v63 quad_perm:[2,2,3,3] row_mask:0xf bank_mask:0xf
    v_mov_b32_dpp v88, v64 quad_perm:[2,2,3,3] row_mask:0xf bank_mask:0xf
    v_mov_b32_dpp v89, v65 quad_perm:[2,2,3,3] row_mask:0xf bank_mask:0xf
    v_mov_b32_dpp v90, v66 quad_perm:[2,2,3,3] row_mask:0xf bank_mask:0xf
    v_mov_b32_dpp v91, v67 quad_perm:[2,2,3,3] row_mask:0xf bank_mask:0xf
    v_mov_b32_dpp v92, v68 quad_perm:[2,2,3,3] row_mask:0xf bank_mask:0xf
    v_mov_b32_dpp v93, v69 quad_perm:[2,2,3,3] row_mask:0xf bank_mask:0xf
    v_mov_b32_dpp v94, v70 quad_perm:[2,2,3,3] row_mask:0xf bank_mask:0xf
    v_mov_b32_dpp v95, v71 quad_perm:[2,2,3,3] row_mask:0xf bank_mask:0xf
    s_waitcnt lgkmcnt(0)
    v_mfma_f32_16x16x32_bf16 v[96:99], a[0:3], v[24:27], v[72:75]
    v_mfma_f32_16x16x32_bf16 v[96:99], a[4:7], v[28:31], v[96:99]
    v_mfma_f32_16x16x32_bf16 v[96:99], a[8:11], v[32:35], v[96:99]
    v_mfma_f32_16x16x32_bf16 v[100:103], a[12:15], v[24:27], v[76:79]
    v_mfma_f32_16x16x32_bf16 v[100:103], a[16:19], v[28:31], v[100:103]
    v_mfma_f32_16x16x32_bf16 v[100:103], a[20:23], v[32:35], v[100:103]
    v_mfma_f32_16x16x32_bf16 v[104:107], a[24:27], v[24:27], v[80:83]
    v_mfma_f32_16x16x32_bf16 v[104:107], a[28:31], v[28:31], v[104:107]
    v_mfma_f32_16x16x32_bf16 v[104:107], a[32:35], v[32:35], v[104:107]
    v_mfma_f32_16x16x32_bf16 v[108:111], a[36:39], v[24:27], v[84:87]
    v_mfma_f32_16x16x32_bf16 v[108:111], a[40:43], v[28:31], v[108:111]
    v_mfma_f32_16x16x32_bf16 v[108:111], a[44:47], v[32:35], v[108:111]
    v_mfma_f32_16x16x32_bf16 v[112:115], a[48:51], v[24:27], v[88:91]
    v_cvt_pk_bf16_f32 v120, v96, v97
    v_mfma_f32_16x16x32_bf16 v[112:115], a[52:55], v[28:31], v[112:115]
    v_cvt_pk_bf16_f32 v121, v98, v99
    v_mfma_f32_16x16x32_bf16 v[112:115], a[56:59], v[32:35], v[112:115]
    v_cvt_pk_bf16_f32 v122, v100, v101
    v_mfma_f32_16x16x32_bf16 v[116:119], a[60:63], v[24:27], v[92:95]
    v_cvt_pk_bf16_f32 v123, v102, v103
    v_mfma_f32_16x16x32_bf16 v[116:119], a[64:67], v[28:31], v[116:119]
    ds_write_b128 v6, v[120:123] offset:0
    v_mfma_f32_16x16x32_bf16 v[116:119], a[68:71], v[32:35], v[116:119]
    v_cvt_pk_bf16_f32 v124, v104, v105
    v_cvt_pk_bf16_f32 v125, v106, v107
    v_cvt_pk_bf16_f32 v126, v108, v109
    v_cvt_pk_bf16_f32 v127, v110, v111
    ds_write_b128 v6, v[124:127] offset:64
    s_nop 0
    v_cvt_pk_bf16_f32 v128, v112, v113
    v_cvt_pk_bf16_f32 v129, v114, v115
    v_cvt_pk_bf16_f32 v130, v116, v117
    v_cvt_pk_bf16_f32 v131, v118, v119
    ds_write_b128 v6, v[128:131] offset:128
    ds_read_b128 v[132:135], v8
    ds_read_b128 v[136:139], v9
    ds_read_b128 v[140:143], v10
    s_waitcnt lgkmcnt(2)
    buffer_store_dwordx4 v[132:135], v1, s[28:31], s77 offen offset:0 sc1
    s_waitcnt lgkmcnt(1)
    buffer_store_dwordx4 v[136:139], v1, s[28:31], s77 offen offset:1024 sc1
    s_waitcnt lgkmcnt(0)
    buffer_store_dwordx4 v[140:143], v1, s[28:31], s77 offen offset:2048 sc1
    s_waitcnt vmcnt(24)
    ds_read_b128 v[24:27], v4 offset:9216
    ds_read_b128 v[28:31], v4 offset:9280
    ds_read_b128 v[32:35], v4 offset:9344
    s_add_u32 m0, s33, 6144
    s_add_u32 s43, s79, 98304
    buffer_load_dwordx4 v205, s[16:19], s43 offen offset:0 nt lds
    buffer_load_dwordx4 v208, s[16:19], s43 offen offset:1024 nt lds
    buffer_load_dwordx4 v209, s[16:19], s43 offen offset:2048 nt lds
    s_add_u32 s3, s41, 25
    s_and_b32 s3, s3, 31
    s_add_u32 s3, s3, 160
    s_mul_i32 s37, s3, 49152
    s_add_u32 s89, s37, s12
    s_add_u32 s3, s37, s89
    s_lshl_b32 s81, s3, 1
    s_bitcmp1_b32 s38, 5
    s_cselect_b64 vcc, -1, 0
    v_cndmask_b32 v212, v189, v194, vcc
    v_xor_b32 v212, 32, v212
    v_cndmask_b32 v213, v190, v195, vcc
    v_xor_b32 v213, 32, v213
    s_add_u32 m0, s33, 16896
    s_nop 0
    buffer_load_dwordx4 v212, s[20:23], s89 offen nt lds
    s_waitcnt lgkmcnt(0)
    v_mfma_f32_16x16x32_bf16 v[96:99], a[0:3], v[24:27], v[72:75]
    v_mfma_f32_16x16x32_bf16 v[96:99], a[4:7], v[28:31], v[96:99]
    v_mfma_f32_16x16x32_bf16 v[96:99], a[8:11], v[32:35], v[96:99]
    v_mfma_f32_16x16x32_bf16 v[100:103], a[12:15], v[24:27], v[76:79]
    v_mfma_f32_16x16x32_bf16 v[100:103], a[16:19], v[28:31], v[100:103]
    v_mfma_f32_16x16x32_bf16 v[100:103], a[20:23], v[32:35], v[100:103]
    v_mfma_f32_16x16x32_bf16 v[104:107], a[24:27], v[24:27], v[80:83]
    v_mfma_f32_16x16x32_bf16 v[104:107], a[28:31], v[28:31], v[104:107]
    v_mfma_f32_16x16x32_bf16 v[104:107], a[32:35], v[32:35], v[104:107]
    v_mfma_f32_16x16x32_bf16 v[108:111], a[36:39], v[24:27], v[84:87]
    v_mfma_f32_16x16x32_bf16 v[108:111], a[40:43], v[28:31], v[108:111]
    v_mfma_f32_16x16x32_bf16 v[108:111], a[44:47], v[32:35], v[108:111]
    v_mfma_f32_16x16x32_bf16 v[112:115], a[48:51], v[24:27], v[88:91]
    v_cvt_pk_bf16_f32 v120, v96, v97
    v_mfma_f32_16x16x32_bf16 v[112:115], a[52:55], v[28:31], v[112:115]
    v_cvt_pk_bf16_f32 v121, v98, v99
    v_mfma_f32_16x16x32_bf16 v[112:115], a[56:59], v[32:35], v[112:115]
    v_cvt_pk_bf16_f32 v122, v100, v101
    v_mfma_f32_16x16x32_bf16 v[116:119], a[60:63], v[24:27], v[92:95]
    v_cvt_pk_bf16_f32 v123, v102, v103
    v_mfma_f32_16x16x32_bf16 v[116:119], a[64:67], v[28:31], v[116:119]
    ds_write_b128 v6, v[120:123] offset:0
    v_mfma_f32_16x16x32_bf16 v[116:119], a[68:71], v[32:35], v[116:119]
    v_cvt_pk_bf16_f32 v124, v104, v105
    v_cvt_pk_bf16_f32 v125, v106, v107
    v_cvt_pk_bf16_f32 v126, v108, v109
    v_cvt_pk_bf16_f32 v127, v110, v111
    ds_write_b128 v6, v[124:127] offset:64
    s_add_u32 s32, s77, 98304
    v_cvt_pk_bf16_f32 v128, v112, v113
    v_cvt_pk_bf16_f32 v129, v114, v115
    v_cvt_pk_bf16_f32 v130, v116, v117
    v_cvt_pk_bf16_f32 v131, v118, v119
    ds_write_b128 v6, v[128:131] offset:128
    ds_read_b128 v[132:135], v8
    ds_read_b128 v[136:139], v9
    ds_read_b128 v[140:143], v10
    s_waitcnt lgkmcnt(2)
    buffer_store_dwordx4 v[132:135], v1, s[28:31], s32 offen offset:0 sc1
    s_waitcnt lgkmcnt(1)
    buffer_store_dwordx4 v[136:139], v1, s[28:31], s32 offen offset:1024 sc1
    s_waitcnt lgkmcnt(0)
    buffer_store_dwordx4 v[140:143], v1, s[28:31], s32 offen offset:2048 sc1
    s_barrier
    s_waitcnt vmcnt(24)
    ds_read_b128 v[36:39], v5 offset:18432
    ds_read_b128 v[40:43], v5 offset:18496
    ds_read_b128 v[44:47], v5 offset:18560
    ds_read_b128 v[24:27], v4 offset:12288
    ds_read_b128 v[28:31], v4 offset:12352
    ds_read_b128 v[32:35], v4 offset:12416
    s_mov_b32 exec_hi, 0
    buffer_load_dwordx4 v213, s[20:23], s89 offen offset:1024 nt lds
    s_mov_b32 exec_hi, -1
    s_bitcmp1_b32 s38, 4
    s_cselect_b64 vcc, -1, 0
    v_cndmask_b32 v196, v186, v191, vcc
    v_cndmask_b32 v197, v187, v192, vcc
    v_cndmask_b32 v198, v188, v193, vcc
    v_xor_b32 v208, v7, v197
    v_xor_b32 v209, 32, v198
    s_add_u32 m0, s33, 9216
    s_nop 0
    buffer_load_dwordx4 v196, s[16:19], s80 offen offset:0 nt lds
    buffer_load_dwordx4 v208, s[16:19], s80 offen offset:1024 nt lds
    buffer_load_dwordx4 v209, s[16:19], s80 offen offset:2048 nt lds
    s_waitcnt lgkmcnt(3)
    v_mfma_f32_16x16x32_bf16 v[48:51], a[72:75], v[36:39], 0
    v_mfma_f32_16x16x32_bf16 v[48:51], a[76:79], v[40:43], v[48:51]
    v_mfma_f32_16x16x32_bf16 v[48:51], a[80:83], v[44:47], v[48:51]
    v_mfma_f32_16x16x32_bf16 v[52:55], a[84:87], v[36:39], 0
    v_mfma_f32_16x16x32_bf16 v[52:55], a[88:91], v[40:43], v[52:55]
    v_mfma_f32_16x16x32_bf16 v[52:55], a[92:95], v[44:47], v[52:55]
    v_mfma_f32_16x16x32_bf16 v[56:59], a[96:99], v[36:39], 0
    v_mfma_f32_16x16x32_bf16 v[56:59], a[100:103], v[40:43], v[56:59]
    v_mfma_f32_16x16x32_bf16 v[56:59], a[104:107], v[44:47], v[56:59]
    v_mfma_f32_16x16x32_bf16 v[60:63], a[108:111], v[36:39], 0
    v_mfma_f32_16x16x32_bf16 v[60:63], a[112:115], v[40:43], v[60:63]
    v_mfma_f32_16x16x32_bf16 v[60:63], a[116:119], v[44:47], v[60:63]
    v_mov_b32_dpp v72, v48 quad_perm:[0,0,1,1] row_mask:0xf bank_mask:0xf
    v_mov_b32_dpp v73, v49 quad_perm:[0,0,1,1] row_mask:0xf bank_mask:0xf
    v_mfma_f32_16x16x32_bf16 v[64:67], a[120:123], v[36:39], 0
    v_mov_b32_dpp v74, v50 quad_perm:[0,0,1,1] row_mask:0xf bank_mask:0xf
    v_mov_b32_dpp v75, v51 quad_perm:[0,0,1,1] row_mask:0xf bank_mask:0xf
    v_mfma_f32_16x16x32_bf16 v[64:67], a[124:127], v[40:43], v[64:67]
    v_mov_b32_dpp v76, v52 quad_perm:[0,0,1,1] row_mask:0xf bank_mask:0xf
    v_mov_b32_dpp v77, v53 quad_perm:[0,0,1,1] row_mask:0xf bank_mask:0xf
    v_mfma_f32_16x16x32_bf16 v[64:67], a[128:131], v[44:47], v[64:67]
    v_mov_b32_dpp v78, v54 quad_perm:[0,0,1,1] row_mask:0xf bank_mask:0xf
    v_mov_b32_dpp v79, v55 quad_perm:[0,0,1,1] row_mask:0xf bank_mask:0xf
    v_mfma_f32_16x16x32_bf16 v[68:71], a[132:135], v[36:39], 0
    v_mov_b32_dpp v80, v56 quad_perm:[0,0,1,1] row_mask:0xf bank_mask:0xf
    v_mov_b32_dpp v81, v57 quad_perm:[0,0,1,1] row_mask:0xf bank_mask:0xf
    v_mfma_f32_16x16x32_bf16 v[68:71], a[136:139], v[40:43], v[68:71]
    v_mov_b32_dpp v82, v58 quad_perm:[0,0,1,1] row_mask:0xf bank_mask:0xf
    v_mov_b32_dpp v83, v59 quad_perm:[0,0,1,1] row_mask:0xf bank_mask:0xf
    v_mfma_f32_16x16x32_bf16 v[68:71], a[140:143], v[44:47], v[68:71]
    v_mov_b32_dpp v84, v60 quad_perm:[0,0,1,1] row_mask:0xf bank_mask:0xf
    v_mov_b32_dpp v85, v61 quad_perm:[0,0,1,1] row_mask:0xf bank_mask:0xf
    v_mov_b32_dpp v86, v62 quad_perm:[0,0,1,1] row_mask:0xf bank_mask:0xf
    v_mov_b32_dpp v87, v63 quad_perm:[0,0,1,1] row_mask:0xf bank_mask:0xf
    v_mov_b32_dpp v88, v64 quad_perm:[0,0,1,1] row_mask:0xf bank_mask:0xf
    v_mov_b32_dpp v89, v65 quad_perm:[0,0,1,1] row_mask:0xf bank_mask:0xf
    v_mov_b32_dpp v90, v66 quad_perm:[0,0,1,1] row_mask:0xf bank_mask:0xf
    v_mov_b32_dpp v91, v67 quad_perm:[0,0,1,1] row_mask:0xf bank_mask:0xf
    v_mov_b32_dpp v92, v68 quad_perm:[0,0,1,1] row_mask:0xf bank_mask:0xf
    v_mov_b32_dpp v93, v69 quad_perm:[0,0,1,1] row_mask:0xf bank_mask:0xf
    v_mov_b32_dpp v94, v70 quad_perm:[0,0,1,1] row_mask:0xf bank_mask:0xf
    v_mov_b32_dpp v95, v71 quad_perm:[0,0,1,1] row_mask:0xf bank_mask:0xf
    s_waitcnt lgkmcnt(0)
    v_mfma_f32_16x16x32_bf16 v[96:99], a[0:3], v[24:27], v[72:75]
    v_mfma_f32_16x16x32_bf16 v[96:99], a[4:7], v[28:31], v[96:99]
    v_mfma_f32_16x16x32_bf16 v[96:99], a[8:11], v[32:35], v[96:99]
    v_mfma_f32_16x16x32_bf16 v[100:103], a[12:15], v[24:27], v[76:79]
    v_mfma_f32_16x16x32_bf16 v[100:103], a[16:19], v[28:31], v[100:103]
    v_mfma_f32_16x16x32_bf16 v[100:103], a[20:23], v[32:35], v[100:103]
    v_mfma_f32_16x16x32_bf16 v[104:107], a[24:27], v[24:27], v[80:83]
    v_mfma_f32_16x16x32_bf16 v[104:107], a[28:31], v[28:31], v[104:107]
    v_mfma_f32_16x16x32_bf16 v[104:107], a[32:35], v[32:35], v[104:107]
    v_mfma_f32_16x16x32_bf16 v[108:111], a[36:39], v[24:27], v[84:87]
    v_mfma_f32_16x16x32_bf16 v[108:111], a[40:43], v[28:31], v[108:111]
    v_mfma_f32_16x16x32_bf16 v[108:111], a[44:47], v[32:35], v[108:111]
    v_mfma_f32_16x16x32_bf16 v[112:115], a[48:51], v[24:27], v[88:91]
    v_cvt_pk_bf16_f32 v120, v96, v97
    v_mfma_f32_16x16x32_bf16 v[112:115], a[52:55], v[28:31], v[112:115]
    v_cvt_pk_bf16_f32 v121, v98, v99
    v_mfma_f32_16x16x32_bf16 v[112:115], a[56:59], v[32:35], v[112:115]
    v_cvt_pk_bf16_f32 v122, v100, v101
    v_mfma_f32_16x16x32_bf16 v[116:119], a[60:63], v[24:27], v[92:95]
    v_cvt_pk_bf16_f32 v123, v102, v103
    v_mfma_f32_16x16x32_bf16 v[116:119], a[64:67], v[28:31], v[116:119]
    ds_write_b128 v6, v[120:123] offset:0
    v_mfma_f32_16x16x32_bf16 v[116:119], a[68:71], v[32:35], v[116:119]
    v_cvt_pk_bf16_f32 v124, v104, v105
    v_cvt_pk_bf16_f32 v125, v106, v107
    v_cvt_pk_bf16_f32 v126, v108, v109
    v_cvt_pk_bf16_f32 v127, v110, v111
    ds_write_b128 v6, v[124:127] offset:64
    s_nop 0
    v_cvt_pk_bf16_f32 v128, v112, v113
    v_cvt_pk_bf16_f32 v129, v114, v115
    v_cvt_pk_bf16_f32 v130, v116, v117
    v_cvt_pk_bf16_f32 v131, v118, v119
    ds_write_b128 v6, v[128:131] offset:128
    ds_read_b128 v[132:135], v8
    ds_read_b128 v[136:139], v9
    ds_read_b128 v[140:143], v10
    s_waitcnt lgkmcnt(2)
    buffer_store_dwordx4 v[132:135], v202, s[28:31], s78 offen offset:0 sc1
    s_waitcnt lgkmcnt(1)
    buffer_store_dwordx4 v[136:139], v203, s[28:31], s78 offen offset:1024 sc1
    s_waitcnt lgkmcnt(0)
    buffer_store_dwordx4 v[140:143], v204, s[28:31], s78 offen offset:2048 sc1
    s_waitcnt vmcnt(24)
    ds_read_b128 v[24:27], v4 offset:0
    ds_read_b128 v[28:31], v4 offset:64
    ds_read_b128 v[32:35], v4 offset:128
    s_waitcnt lgkmcnt(0)
    v_mfma_f32_16x16x32_bf16 v[96:99], a[0:3], v[24:27], v[72:75]
    v_mfma_f32_16x16x32_bf16 v[96:99], a[4:7], v[28:31], v[96:99]
    v_mfma_f32_16x16x32_bf16 v[96:99], a[8:11], v[32:35], v[96:99]
    v_mfma_f32_16x16x32_bf16 v[100:103], a[12:15], v[24:27], v[76:79]
    v_mfma_f32_16x16x32_bf16 v[100:103], a[16:19], v[28:31], v[100:103]
    v_mfma_f32_16x16x32_bf16 v[100:103], a[20:23], v[32:35], v[100:103]
    v_mfma_f32_16x16x32_bf16 v[104:107], a[24:27], v[24:27], v[80:83]
    v_mfma_f32_16x16x32_bf16 v[104:107], a[28:31], v[28:31], v[104:107]
    v_mfma_f32_16x16x32_bf16 v[104:107], a[32:35], v[32:35], v[104:107]
    v_mfma_f32_16x16x32_bf16 v[108:111], a[36:39], v[24:27], v[84:87]
    v_mfma_f32_16x16x32_bf16 v[108:111], a[40:43], v[28:31], v[108:111]
    v_mfma_f32_16x16x32_bf16 v[108:111], a[44:47], v[32:35], v[108:111]
    v_mfma_f32_16x16x32_bf16 v[112:115], a[48:51], v[24:27], v[88:91]
    v_cvt_pk_bf16_f32 v120, v96, v97
    v_mfma_f32_16x16x32_bf16 v[112:115], a[52:55], v[28:31], v[112:115]
    v_cvt_pk_bf16_f32 v121, v98, v99
    v_mfma_f32_16x16x32_bf16 v[112:115], a[56:59], v[32:35], v[112:115]
    v_cvt_pk_bf16_f32 v122, v100, v101
    v_mfma_f32_16x16x32_bf16 v[116:119], a[60:63], v[24:27], v[92:95]
    v_cvt_pk_bf16_f32 v123, v102, v103
    v_mfma_f32_16x16x32_bf16 v[116:119], a[64:67], v[28:31], v[116:119]
    ds_write_b128 v6, v[120:123] offset:0
    v_mfma_f32_16x16x32_bf16 v[116:119], a[68:71], v[32:35], v[116:119]
    v_cvt_pk_bf16_f32 v124, v104, v105
    v_cvt_pk_bf16_f32 v125, v106, v107
    v_cvt_pk_bf16_f32 v126, v108, v109
    v_cvt_pk_bf16_f32 v127, v110, v111
    ds_write_b128 v6, v[124:127] offset:64
    s_add_u32 s32, s78, 98304
    v_cvt_pk_bf16_f32 v128, v112, v113
    v_cvt_pk_bf16_f32 v129, v114, v115
    v_cvt_pk_bf16_f32 v130, v116, v117
    v_cvt_pk_bf16_f32 v131, v118, v119
    ds_write_b128 v6, v[128:131] offset:128
    ds_read_b128 v[132:135], v8
    ds_read_b128 v[136:139], v9
    ds_read_b128 v[140:143], v10
    s_waitcnt lgkmcnt(2)
    buffer_store_dwordx4 v[132:135], v202, s[28:31], s32 offen offset:0 sc1
    s_waitcnt lgkmcnt(1)
    buffer_store_dwordx4 v[136:139], v203, s[28:31], s32 offen offset:1024 sc1
    s_waitcnt lgkmcnt(0)
    buffer_store_dwordx4 v[140:143], v204, s[28:31], s32 offen offset:2048 sc1
    s_waitcnt vmcnt(20)
    ds_read_b128 v[24:27], v4 offset:3072
    ds_read_b128 v[28:31], v4 offset:3136
    ds_read_b128 v[32:35], v4 offset:3200
    s_add_u32 m0, s33, 12288
    s_add_u32 s43, s80, 98304
    buffer_load_dwordx4 v196, s[16:19], s43 offen offset:0 nt lds
    buffer_load_dwordx4 v208, s[16:19], s43 offen offset:1024 nt lds
    buffer_load_dwordx4 v209, s[16:19], s43 offen offset:2048 nt lds
    s_add_u32 s3, s41, 30
    s_and_b32 s3, s3, 31
    s_add_u32 s3, s3, 192
    s_mul_i32 s37, s3, 49152
    s_add_u32 s90, s37, s12
    s_add_u32 s3, s37, s90
    s_lshl_b32 s82, s3, 1
    s_bitcmp1_b32 s38, 6
    s_cselect_b64 vcc, -1, 0
    v_cndmask_b32 v210, v189, v194, vcc
    v_cndmask_b32 v211, v190, v195, vcc
    s_add_u32 m0, s33, 18432
    s_nop 0
    buffer_load_dwordx4 v210, s[20:23], s90 offen nt lds
    v_mov_b32_dpp v72, v48 quad_perm:[2,2,3,3] row_mask:0xf bank_mask:0xf
    v_mov_b32_dpp v73, v49 quad_perm:[2,2,3,3] row_mask:0xf bank_mask:0xf
    v_mov_b32_dpp v74, v50 quad_perm:[2,2,3,3] row_mask:0xf bank_mask:0xf
    v_mov_b32_dpp v75, v51 quad_perm:[2,2,3,3] row_mask:0xf bank_mask:0xf
    v_mov_b32_dpp v76, v52 quad_perm:[2,2,3,3] row_mask:0xf bank_mask:0xf
    v_mov_b32_dpp v77, v53 quad_perm:[2,2,3,3] row_mask:0xf bank_mask:0xf
    v_mov_b32_dpp v78, v54 quad_perm:[2,2,3,3] row_mask:0xf bank_mask:0xf
    v_mov_b32_dpp v79, v55 quad_perm:[2,2,3,3] row_mask:0xf bank_mask:0xf
    v_mov_b32_dpp v80, v56 quad_perm:[2,2,3,3] row_mask:0xf bank_mask:0xf
    v_mov_b32_dpp v81, v57 quad_perm:[2,2,3,3] row_mask:0xf bank_mask:0xf
    v_mov_b32_dpp v82, v58 quad_perm:[2,2,3,3] row_mask:0xf bank_mask:0xf
    v_mov_b32_dpp v83, v59 quad_perm:[2,2,3,3] row_mask:0xf bank_mask:0xf
    v_mov_b32_dpp v84, v60 quad_perm:[2,2,3,3] row_mask:0xf bank_mask:0xf
    v_mov_b32_dpp v85, v61 quad_perm:[2,2,3,3] row_mask:0xf bank_mask:0xf
    v_mov_b32_dpp v86, v62 quad_perm:[2,2,3,3] row_mask:0xf bank_mask:0xf
    v_mov_b32_dpp v87, v63 quad_perm:[2,2,3,3] row_mask:0xf bank_mask:0xf
    v_mov_b32_dpp v88, v64 quad_perm:[2,2,3,3] row_mask:0xf bank_mask:0xf
    v_mov_b32_dpp v89, v65 quad_perm:[2,2,3,3] row_mask:0xf bank_mask:0xf
    v_mov_b32_dpp v90, v66 quad_perm:[2,2,3,3] row_mask:0xf bank_mask:0xf
    v_mov_b32_dpp v91, v67 quad_perm:[2,2,3,3] row_mask:0xf bank_mask:0xf
    v_mov_b32_dpp v92, v68 quad_perm:[2,2,3,3] row_mask:0xf bank_mask:0xf
    v_mov_b32_dpp v93, v69 quad_perm:[2,2,3,3] row_mask:0xf bank_mask:0xf
    v_mov_b32_dpp v94, v70 quad_perm:[2,2,3,3] row_mask:0xf bank_mask:0xf
    v_mov_b32_dpp v95, v71 quad_perm:[2,2,3,3] row_mask:0xf bank_mask:0xf
    s_waitcnt lgkmcnt(0)
    v_mfma_f32_16x16x32_bf16 v[96:99], a[0:3], v[24:27], v[72:75]
    v_mfma_f32_16x16x32_bf16 v[96:99], a[4:7], v[28:31], v[96:99]
    v_mfma_f32_16x16x32_bf16 v[96:99], a[8:11], v[32:35], v[96:99]
    v_mfma_f32_16x16x32_bf16 v[100:103], a[12:15], v[24:27], v[76:79]
    v_mfma_f32_16x16x32_bf16 v[100:103], a[16:19], v[28:31], v[100:103]
    v_mfma_f32_16x16x32_bf16 v[100:103], a[20:23], v[32:35], v[100:103]
    v_mfma_f32_16x16x32_bf16 v[104:107], a[24:27], v[24:27], v[80:83]
    v_mfma_f32_16x16x32_bf16 v[104:107], a[28:31], v[28:31], v[104:107]
    v_mfma_f32_16x16x32_bf16 v[104:107], a[32:35], v[32:35], v[104:107]
    v_mfma_f32_16x16x32_bf16 v[108:111], a[36:39], v[24:27], v[84:87]
    v_mfma_f32_16x16x32_bf16 v[108:111], a[40:43], v[28:31], v[108:111]
    v_mfma_f32_16x16x32_bf16 v[108:111], a[44:47], v[32:35], v[108:111]
    v_mfma_f32_16x16x32_bf16 v[112:115], a[48:51], v[24:27], v[88:91]
    v_cvt_pk_bf16_f32 v120, v96, v97
    v_mfma_f32_16x16x32_bf16 v[112:115], a[52:55], v[28:31], v[112:115]
    v_cvt_pk_bf16_f32 v121, v98, v99
    v_mfma_f32_16x16x32_bf16 v[112:115], a[56:59], v[32:35], v[112:115]
    v_cvt_pk_bf16_f32 v122, v100, v101
    v_mfma_f32_16x16x32_bf16 v[116:119], a[60:63], v[24:27], v[92:95]
    v_cvt_pk_bf16_f32 v123, v102, v103
    v_mfma_f32_16x16x32_bf16 v[116:119], a[64:67], v[28:31], v[116:119]
    ds_write_b128 v6, v[120:123] offset:0
    v_mfma_f32_16x16x32_bf16 v[116:119], a[68:71], v[32:35], v[116:119]
    v_cvt_pk_bf16_f32 v124, v104, v105
    v_cvt_pk_bf16_f32 v125, v106, v107
    v_cvt_pk_bf16_f32 v126, v108, v109
    v_cvt_pk_bf16_f32 v127, v110, v111
    ds_write_b128 v6, v[124:127] offset:64
    s_nop 0
    v_cvt_pk_bf16_f32 v128, v112, v113
    v_cvt_pk_bf16_f32 v129, v114, v115
    v_cvt_pk_bf16_f32 v130, v116, v117
    v_cvt_pk_bf16_f32 v131, v118, v119
    ds_write_b128 v6, v[128:131] offset:128
    ds_read_b128 v[132:135], v8
    ds_read_b128 v[136:139], v9
    ds_read_b128 v[140:143], v10
    s_waitcnt lgkmcnt(2)
    buffer_store_dwordx4 v[132:135], v205, s[28:31], s79 offen offset:0 sc1
    s_waitcnt lgkmcnt(1)
    buffer_store_dwordx4 v[136:139], v206, s[28:31], s79 offen offset:1024 sc1
    s_waitcnt lgkmcnt(0)
    buffer_store_dwordx4 v[140:143], v207, s[28:31], s79 offen offset:2048 sc1
    s_waitcnt vmcnt(20)
    ds_read_b128 v[24:27], v4 offset:6144
    ds_read_b128 v[28:31], v4 offset:6208
    ds_read_b128 v[32:35], v4 offset:6272
    s_bitcmp1_b32 s38, 5
    s_cselect_b64 vcc, -1, 0
    v_cndmask_b32 v199, v186, v191, vcc
    v_cndmask_b32 v200, v187, v192, vcc
    v_cndmask_b32 v201, v188, v193, vcc
    v_xor_b32 v208, v7, v200
    v_xor_b32 v209, 32, v201
    s_add_u32 m0, s33, 0
    s_nop 0
    buffer_load_dwordx4 v199, s[16:19], s81 offen offset:0 nt lds
    buffer_load_dwordx4 v208, s[16:19], s81 offen offset:1024 nt lds
    buffer_load_dwordx4 v209, s[16:19], s81 offen offset:2048 nt lds
    s_add_u32 m0, s33, 18432
    s_nop 0
    s_mov_b32 exec_hi, 0
    buffer_load_dwordx4 v211, s[20:23], s90 offen offset:1024 nt lds
    s_mov_b32 exec_hi, -1
    s_waitcnt lgkmcnt(0)
    v_mfma_f32_16x16x32_bf16 v[96:99], a[0:3], v[24:27], v[72:75]
    v_mfma_f32_16x16x32_bf16 v[96:99], a[4:7], v[28:31], v[96:99]
    v_mfma_f32_16x16x32_bf16 v[96:99], a[8:11], v[32:35], v[96:99]
    v_mfma_f32_16x16x32_bf16 v[100:103], a[12:15], v[24:27], v[76:79]
    v_mfma_f32_16x16x32_bf16 v[100:103], a[16:19], v[28:31], v[100:103]
    v_mfma_f32_16x16x32_bf16 v[100:103], a[20:23], v[32:35], v[100:103]
    v_mfma_f32_16x16x32_bf16 v[104:107], a[24:27], v[24:27], v[80:83]
    v_mfma_f32_16x16x32_bf16 v[104:107], a[28:31], v[28:31], v[104:107]
    v_mfma_f32_16x16x32_bf16 v[104:107], a[32:35], v[32:35], v[104:107]
    v_mfma_f32_16x16x32_bf16 v[108:111], a[36:39], v[24:27], v[84:87]
    v_mfma_f32_16x16x32_bf16 v[108:111], a[40:43], v[28:31], v[108:111]
    v_mfma_f32_16x16x32_bf16 v[108:111], a[44:47], v[32:35], v[108:111]
    v_mfma_f32_16x16x32_bf16 v[112:115], a[48:51], v[24:27], v[88:91]
    v_cvt_pk_bf16_f32 v120, v96, v97
    v_mfma_f32_16x16x32_bf16 v[112:115], a[52:55], v[28:31], v[112:115]
    v_cvt_pk_bf16_f32 v121, v98, v99
    v_mfma_f32_16x16x32_bf16 v[112:115], a[56:59], v[32:35], v[112:115]
    v_cvt_pk_bf16_f32 v122, v100, v101
    v_mfma_f32_16x16x32_bf16 v[116:119], a[60:63], v[24:27], v[92:95]
    v_cvt_pk_bf16_f32 v123, v102, v103
    v_mfma_f32_16x16x32_bf16 v[116:119], a[64:67], v[28:31], v[116:119]
    ds_write_b128 v6, v[120:123] offset:0
    v_mfma_f32_16x16x32_bf16 v[116:119], a[68:71], v[32:35], v[116:119]
    v_cvt_pk_bf16_f32 v124, v104, v105
    v_cvt_pk_bf16_f32 v125, v106, v107
    v_cvt_pk_bf16_f32 v126, v108, v109
    v_cvt_pk_bf16_f32 v127, v110, v111
    ds_write_b128 v6, v[124:127] offset:64
    s_add_u32 s32, s79, 98304
    v_cvt_pk_bf16_f32 v128, v112, v113
    v_cvt_pk_bf16_f32 v129, v114, v115
    v_cvt_pk_bf16_f32 v130, v116, v117
    v_cvt_pk_bf16_f32 v131, v118, v119
    ds_write_b128 v6, v[128:131] offset:128
    ds_read_b128 v[132:135], v8
    ds_read_b128 v[136:139], v9
    ds_read_b128 v[140:143], v10
    s_waitcnt lgkmcnt(2)
    buffer_store_dwordx4 v[132:135], v205, s[28:31], s32 offen offset:0 sc1
    s_waitcnt lgkmcnt(1)
    buffer_store_dwordx4 v[136:139], v206, s[28:31], s32 offen offset:1024 sc1
    s_waitcnt lgkmcnt(0)
    buffer_store_dwordx4 v[140:143], v207, s[28:31], s32 offen offset:2048 sc1
    s_barrier
    s_waitcnt vmcnt(20)
    ds_read_b128 v[36:39], v5 offset:15360
    ds_read_b128 v[40:43], v5 offset:15424
    ds_read_b128 v[44:47], v5 offset:15488
    ds_read_b128 v[24:27], v4 offset:9216
    ds_read_b128 v[28:31], v4 offset:9280
    ds_read_b128 v[32:35], v4 offset:9344
    s_add_u32 m0, s33, 3072
    s_add_u32 s43, s81, 98304
    buffer_load_dwordx4 v199, s[16:19], s43 offen offset:0 nt lds
    buffer_load_dwordx4 v208, s[16:19], s43 offen offset:1024 nt lds
    buffer_load_dwordx4 v209, s[16:19], s43 offen offset:2048 nt lds
    s_add_u32 s3, s41, 3
    s_and_b32 s3, s3, 31
    s_add_u32 s3, s3, 224
    s_mul_i32 s37, s3, 49152
    s_add_u32 s91, s37, s12
    s_add_u32 s3, s37, s91
    s_lshl_b32 s83, s3, 1
    s_bitcmp1_b32 s38, 7
    s_cselect_b64 vcc, -1, 0
    v_cndmask_b32 v212, v189, v194, vcc
    v_xor_b32 v212, 32, v212
    v_cndmask_b32 v213, v190, v195, vcc
    v_xor_b32 v213, 32, v213
    s_add_u32 m0, s33, 19968
    s_nop 0
    buffer_load_dwordx4 v212, s[20:23], s91 offen nt lds
    s_waitcnt lgkmcnt(3)
    v_mfma_f32_16x16x32_bf16 v[48:51], a[72:75], v[36:39], 0
    v_mfma_f32_16x16x32_bf16 v[48:51], a[76:79], v[40:43], v[48:51]
    v_mfma_f32_16x16x32_bf16 v[48:51], a[80:83], v[44:47], v[48:51]
    v_mfma_f32_16x16x32_bf16 v[52:55], a[84:87], v[36:39], 0
    v_mfma_f32_16x16x32_bf16 v[52:55], a[88:91], v[40:43], v[52:55]
    v_mfma_f32_16x16x32_bf16 v[52:55], a[92:95], v[44:47], v[52:55]
    v_mfma_f32_16x16x32_bf16 v[56:59], a[96:99], v[36:39], 0
    v_mfma_f32_16x16x32_bf16 v[56:59], a[100:103], v[40:43], v[56:59]
    v_mfma_f32_16x16x32_bf16 v[56:59], a[104:107], v[44:47], v[56:59]
    v_mfma_f32_16x16x32_bf16 v[60:63], a[108:111], v[36:39], 0
    v_mfma_f32_16x16x32_bf16 v[60:63], a[112:115], v[40:43], v[60:63]
    v_mfma_f32_16x16x32_bf16 v[60:63], a[116:119], v[44:47], v[60:63]
    v_mov_b32_dpp v72, v48 quad_perm:[0,0,1,1] row_mask:0xf bank_mask:0xf
    v_mov_b32_dpp v73, v49 quad_perm:[0,0,1,1] row_mask:0xf bank_mask:0xf
    v_mfma_f32_16x16x32_bf16 v[64:67], a[120:123], v[36:39], 0
    v_mov_b32_dpp v74, v50 quad_perm:[0,0,1,1] row_mask:0xf bank_mask:0xf
    v_mov_b32_dpp v75, v51 quad_perm:[0,0,1,1] row_mask:0xf bank_mask:0xf
    v_mfma_f32_16x16x32_bf16 v[64:67], a[124:127], v[40:43], v[64:67]
    v_mov_b32_dpp v76, v52 quad_perm:[0,0,1,1] row_mask:0xf bank_mask:0xf
    v_mov_b32_dpp v77, v53 quad_perm:[0,0,1,1] row_mask:0xf bank_mask:0xf
    v_mfma_f32_16x16x32_bf16 v[64:67], a[128:131], v[44:47], v[64:67]
    v_mov_b32_dpp v78, v54 quad_perm:[0,0,1,1] row_mask:0xf bank_mask:0xf
    v_mov_b32_dpp v79, v55 quad_perm:[0,0,1,1] row_mask:0xf bank_mask:0xf
    v_mfma_f32_16x16x32_bf16 v[68:71], a[132:135], v[36:39], 0
    v_mov_b32_dpp v80, v56 quad_perm:[0,0,1,1] row_mask:0xf bank_mask:0xf
    v_mov_b32_dpp v81, v57 quad_perm:[0,0,1,1] row_mask:0xf bank_mask:0xf
    v_mfma_f32_16x16x32_bf16 v[68:71], a[136:139], v[40:43], v[68:71]
    v_mov_b32_dpp v82, v58 quad_perm:[0,0,1,1] row_mask:0xf bank_mask:0xf
    v_mov_b32_dpp v83, v59 quad_perm:[0,0,1,1] row_mask:0xf bank_mask:0xf
    v_mfma_f32_16x16x32_bf16 v[68:71], a[140:143], v[44:47], v[68:71]
    v_mov_b32_dpp v84, v60 quad_perm:[0,0,1,1] row_mask:0xf bank_mask:0xf
    v_mov_b32_dpp v85, v61 quad_perm:[0,0,1,1] row_mask:0xf bank_mask:0xf
    v_mov_b32_dpp v86, v62 quad_perm:[0,0,1,1] row_mask:0xf bank_mask:0xf
    v_mov_b32_dpp v87, v63 quad_perm:[0,0,1,1] row_mask:0xf bank_mask:0xf
    v_mov_b32_dpp v88, v64 quad_perm:[0,0,1,1] row_mask:0xf bank_mask:0xf
    v_mov_b32_dpp v89, v65 quad_perm:[0,0,1,1] row_mask:0xf bank_mask:0xf
    v_mov_b32_dpp v90, v66 quad_perm:[0,0,1,1] row_mask:0xf bank_mask:0xf
    v_mov_b32_dpp v91, v67 quad_perm:[0,0,1,1] row_mask:0xf bank_mask:0xf
    v_mov_b32_dpp v92, v68 quad_perm:[0,0,1,1] row_mask:0xf bank_mask:0xf
    v_mov_b32_dpp v93, v69 quad_perm:[0,0,1,1] row_mask:0xf bank_mask:0xf
    v_mov_b32_dpp v94, v70 quad_perm:[0,0,1,1] row_mask:0xf bank_mask:0xf
    v_mov_b32_dpp v95, v71 quad_perm:[0,0,1,1] row_mask:0xf bank_mask:0xf
    s_waitcnt lgkmcnt(0)
    v_mfma_f32_16x16x32_bf16 v[96:99], a[0:3], v[24:27], v[72:75]
    v_mfma_f32_16x16x32_bf16 v[96:99], a[4:7], v[28:31], v[96:99]
    v_mfma_f32_16x16x32_bf16 v[96:99], a[8:11], v[32:35], v[96:99]
    v_mfma_f32_16x16x32_bf16 v[100:103], a[12:15], v[24:27], v[76:79]
    v_mfma_f32_16x16x32_bf16 v[100:103], a[16:19], v[28:31], v[100:103]
    v_mfma_f32_16x16x32_bf16 v[100:103], a[20:23], v[32:35], v[100:103]
    v_mfma_f32_16x16x32_bf16 v[104:107], a[24:27], v[24:27], v[80:83]
    v_mfma_f32_16x16x32_bf16 v[104:107], a[28:31], v[28:31], v[104:107]
    v_mfma_f32_16x16x32_bf16 v[104:107], a[32:35], v[32:35], v[104:107]
    v_mfma_f32_16x16x32_bf16 v[108:111], a[36:39], v[24:27], v[84:87]
    v_mfma_f32_16x16x32_bf16 v[108:111], a[40:43], v[28:31], v[108:111]
    v_mfma_f32_16x16x32_bf16 v[108:111], a[44:47], v[32:35], v[108:111]
    v_mfma_f32_16x16x32_bf16 v[112:115], a[48:51], v[24:27], v[88:91]
    v_cvt_pk_bf16_f32 v120, v96, v97
    v_mfma_f32_16x16x32_bf16 v[112:115], a[52:55], v[28:31], v[112:115]
    v_cvt_pk_bf16_f32 v121, v98, v99
    v_mfma_f32_16x16x32_bf16 v[112:115], a[56:59], v[32:35], v[112:115]
    v_cvt_pk_bf16_f32 v122, v100, v101
    v_mfma_f32_16x16x32_bf16 v[116:119], a[60:63], v[24:27], v[92:95]
    v_cvt_pk_bf16_f32 v123, v102, v103
    v_mfma_f32_16x16x32_bf16 v[116:119], a[64:67], v[28:31], v[116:119]
    ds_write_b128 v6, v[120:123] offset:0
    v_mfma_f32_16x16x32_bf16 v[116:119], a[68:71], v[32:35], v[116:119]
    v_cvt_pk_bf16_f32 v124, v104, v105
    v_cvt_pk_bf16_f32 v125, v106, v107
    v_cvt_pk_bf16_f32 v126, v108, v109
    v_cvt_pk_bf16_f32 v127, v110, v111
    ds_write_b128 v6, v[124:127] offset:64
    s_nop 0
    v_cvt_pk_bf16_f32 v128, v112, v113
    v_cvt_pk_bf16_f32 v129, v114, v115
    v_cvt_pk_bf16_f32 v130, v116, v117
    v_cvt_pk_bf16_f32 v131, v118, v119
    ds_write_b128 v6, v[128:131] offset:128
    ds_read_b128 v[132:135], v8
    ds_read_b128 v[136:139], v9
    ds_read_b128 v[140:143], v10
    s_waitcnt lgkmcnt(2)
    buffer_store_dwordx4 v[132:135], v196, s[28:31], s80 offen offset:0 sc1
    s_waitcnt lgkmcnt(1)
    buffer_store_dwordx4 v[136:139], v197, s[28:31], s80 offen offset:1024 sc1
    s_waitcnt lgkmcnt(0)
    buffer_store_dwordx4 v[140:143], v198, s[28:31], s80 offen offset:2048 sc1
    s_waitcnt vmcnt(17)
    ds_read_b128 v[24:27], v4 offset:12288
    ds_read_b128 v[28:31], v4 offset:12352
    ds_read_b128 v[32:35], v4 offset:12416
    s_mov_b32 exec_hi, 0
    buffer_load_dwordx4 v213, s[20:23], s91 offen offset:1024 nt lds
    s_mov_b32 exec_hi, -1
    s_bitcmp1_b32 s38, 6
    s_cselect_b64 vcc, -1, 0
    v_cndmask_b32 v202, v186, v191, vcc
    v_cndmask_b32 v203, v187, v192, vcc
    v_cndmask_b32 v204, v188, v193, vcc
    v_xor_b32 v208, v7, v203
    v_xor_b32 v209, 32, v204
    s_add_u32 m0, s33, 6144
    s_nop 0
    buffer_load_dwordx4 v202, s[16:19], s82 offen offset:0 nt lds
    buffer_load_dwordx4 v208, s[16:19], s82 offen offset:1024 nt lds
    buffer_load_dwordx4 v209, s[16:19], s82 offen offset:2048 nt lds
    s_waitcnt lgkmcnt(0)
    v_mfma_f32_16x16x32_bf16 v[96:99], a[0:3], v[24:27], v[72:75]
    v_mfma_f32_16x16x32_bf16 v[96:99], a[4:7], v[28:31], v[96:99]
    v_mfma_f32_16x16x32_bf16 v[96:99], a[8:11], v[32:35], v[96:99]
    v_mfma_f32_16x16x32_bf16 v[100:103], a[12:15], v[24:27], v[76:79]
    v_mfma_f32_16x16x32_bf16 v[100:103], a[16:19], v[28:31], v[100:103]
    v_mfma_f32_16x16x32_bf16 v[100:103], a[20:23], v[32:35], v[100:103]
    v_mfma_f32_16x16x32_bf16 v[104:107], a[24:27], v[24:27], v[80:83]
    v_mfma_f32_16x16x32_bf16 v[104:107], a[28:31], v[28:31], v[104:107]
    v_mfma_f32_16x16x32_bf16 v[104:107], a[32:35], v[32:35], v[104:107]
    v_mfma_f32_16x16x32_bf16 v[108:111], a[36:39], v[24:27], v[84:87]
    v_mfma_f32_16x16x32_bf16 v[108:111], a[40:43], v[28:31], v[108:111]
    v_mfma_f32_16x16x32_bf16 v[108:111], a[44:47], v[32:35], v[108:111]
    v_mfma_f32_16x16x32_bf16 v[112:115], a[48:51], v[24:27], v[88:91]
    v_cvt_pk_bf16_f32 v120, v96, v97
    v_mfma_f32_16x16x32_bf16 v[112:115], a[52:55], v[28:31], v[112:115]
    v_cvt_pk_bf16_f32 v121, v98, v99
    v_mfma_f32_16x16x32_bf16 v[112:115], a[56:59], v[32:35], v[112:115]
    v_cvt_pk_bf16_f32 v122, v100, v101
    v_mfma_f32_16x16x32_bf16 v[116:119], a[60:63], v[24:27], v[92:95]
    v_cvt_pk_bf16_f32 v123, v102, v103
    v_mfma_f32_16x16x32_bf16 v[116:119], a[64:67], v[28:31], v[116:119]
    ds_write_b128 v6, v[120:123] offset:0
    v_mfma_f32_16x16x32_bf16 v[116:119], a[68:71], v[32:35], v[116:119]
    v_cvt_pk_bf16_f32 v124, v104, v105
    v_cvt_pk_bf16_f32 v125, v106, v107
    v_cvt_pk_bf16_f32 v126, v108, v109
    v_cvt_pk_bf16_f32 v127, v110, v111
    ds_write_b128 v6, v[124:127] offset:64
    s_add_u32 s32, s80, 98304
    v_cvt_pk_bf16_f32 v128, v112, v113
    v_cvt_pk_bf16_f32 v129, v114, v115
    v_cvt_pk_bf16_f32 v130, v116, v117
    v_cvt_pk_bf16_f32 v131, v118, v119
    ds_write_b128 v6, v[128:131] offset:128
    ds_read_b128 v[132:135], v8
    ds_read_b128 v[136:139], v9
    ds_read_b128 v[140:143], v10
    s_waitcnt lgkmcnt(2)
    buffer_store_dwordx4 v[132:135], v196, s[28:31], s32 offen offset:0 sc1
    s_waitcnt lgkmcnt(1)
    buffer_store_dwordx4 v[136:139], v197, s[28:31], s32 offen offset:1024 sc1
    s_waitcnt lgkmcnt(0)
    buffer_store_dwordx4 v[140:143], v198, s[28:31], s32 offen offset:2048 sc1
    s_waitcnt vmcnt(17)
    ds_read_b128 v[24:27], v4 offset:0
    ds_read_b128 v[28:31], v4 offset:64
    ds_read_b128 v[32:35], v4 offset:128
    v_mov_b32_dpp v72, v48 quad_perm:[2,2,3,3] row_mask:0xf bank_mask:0xf
    v_mov_b32_dpp v73, v49 quad_perm:[2,2,3,3] row_mask:0xf bank_mask:0xf
    v_mov_b32_dpp v74, v50 quad_perm:[2,2,3,3] row_mask:0xf bank_mask:0xf
    v_mov_b32_dpp v75, v51 quad_perm:[2,2,3,3] row_mask:0xf bank_mask:0xf
    v_mov_b32_dpp v76, v52 quad_perm:[2,2,3,3] row_mask:0xf bank_mask:0xf
    v_mov_b32_dpp v77, v53 quad_perm:[2,2,3,3] row_mask:0xf bank_mask:0xf
    v_mov_b32_dpp v78, v54 quad_perm:[2,2,3,3] row_mask:0xf bank_mask:0xf
    v_mov_b32_dpp v79, v55 quad_perm:[2,2,3,3] row_mask:0xf bank_mask:0xf
    v_mov_b32_dpp v80, v56 quad_perm:[2,2,3,3] row_mask:0xf bank_mask:0xf
    v_mov_b32_dpp v81, v57 quad_perm:[2,2,3,3] row_mask:0xf bank_mask:0xf
    v_mov_b32_dpp v82, v58 quad_perm:[2,2,3,3] row_mask:0xf bank_mask:0xf
    v_mov_b32_dpp v83, v59 quad_perm:[2,2,3,3] row_mask:0xf bank_mask:0xf
    v_mov_b32_dpp v84, v60 quad_perm:[2,2,3,3] row_mask:0xf bank_mask:0xf
    v_mov_b32_dpp v85, v61 quad_perm:[2,2,3,3] row_mask:0xf bank_mask:0xf
    v_mov_b32_dpp v86, v62 quad_perm:[2,2,3,3] row_mask:0xf bank_mask:0xf
    v_mov_b32_dpp v87, v63 quad_perm:[2,2,3,3] row_mask:0xf bank_mask:0xf
    v_mov_b32_dpp v88, v64 quad_perm:[2,2,3,3] row_mask:0xf bank_mask:0xf
    v_mov_b32_dpp v89, v65 quad_perm:[2,2,3,3] row_mask:0xf bank_mask:0xf
    v_mov_b32_dpp v90, v66 quad_perm:[2,2,3,3] row_mask:0xf bank_mask:0xf
    v_mov_b32_dpp v91, v67 quad_perm:[2,2,3,3] row_mask:0xf bank_mask:0xf
    v_mov_b32_dpp v92, v68 quad_perm:[2,2,3,3] row_mask:0xf bank_mask:0xf
    v_mov_b32_dpp v93, v69 quad_perm:[2,2,3,3] row_mask:0xf bank_mask:0xf
    v_mov_b32_dpp v94, v70 quad_perm:[2,2,3,3] row_mask:0xf bank_mask:0xf
    v_mov_b32_dpp v95, v71 quad_perm:[2,2,3,3] row_mask:0xf bank_mask:0xf
    s_waitcnt lgkmcnt(0)
    v_mfma_f32_16x16x32_bf16 v[96:99], a[0:3], v[24:27], v[72:75]
    v_mfma_f32_16x16x32_bf16 v[96:99], a[4:7], v[28:31], v[96:99]
    v_mfma_f32_16x16x32_bf16 v[96:99], a[8:11], v[32:35], v[96:99]
    v_mfma_f32_16x16x32_bf16 v[100:103], a[12:15], v[24:27], v[76:79]
    v_mfma_f32_16x16x32_bf16 v[100:103], a[16:19], v[28:31], v[100:103]
    v_mfma_f32_16x16x32_bf16 v[100:103], a[20:23], v[32:35], v[100:103]
    v_mfma_f32_16x16x32_bf16 v[104:107], a[24:27], v[24:27], v[80:83]
    v_mfma_f32_16x16x32_bf16 v[104:107], a[28:31], v[28:31], v[104:107]
    v_mfma_f32_16x16x32_bf16 v[104:107], a[32:35], v[32:35], v[104:107]
    v_mfma_f32_16x16x32_bf16 v[108:111], a[36:39], v[24:27], v[84:87]
    v_mfma_f32_16x16x32_bf16 v[108:111], a[40:43], v[28:31], v[108:111]
    v_mfma_f32_16x16x32_bf16 v[108:111], a[44:47], v[32:35], v[108:111]
    v_mfma_f32_16x16x32_bf16 v[112:115], a[48:51], v[24:27], v[88:91]
    v_cvt_pk_bf16_f32 v120, v96, v97
    v_mfma_f32_16x16x32_bf16 v[112:115], a[52:55], v[28:31], v[112:115]
    v_cvt_pk_bf16_f32 v121, v98, v99
    v_mfma_f32_16x16x32_bf16 v[112:115], a[56:59], v[32:35], v[112:115]
    v_cvt_pk_bf16_f32 v122, v100, v101
    v_mfma_f32_16x16x32_bf16 v[116:119], a[60:63], v[24:27], v[92:95]
    v_cvt_pk_bf16_f32 v123, v102, v103
    v_mfma_f32_16x16x32_bf16 v[116:119], a[64:67], v[28:31], v[116:119]
    ds_write_b128 v6, v[120:123] offset:0
    v_mfma_f32_16x16x32_bf16 v[116:119], a[68:71], v[32:35], v[116:119]
    v_cvt_pk_bf16_f32 v124, v104, v105
    v_cvt_pk_bf16_f32 v125, v106, v107
    v_cvt_pk_bf16_f32 v126, v108, v109
    v_cvt_pk_bf16_f32 v127, v110, v111
    ds_write_b128 v6, v[124:127] offset:64
    s_nop 0
    v_cvt_pk_bf16_f32 v128, v112, v113
    v_cvt_pk_bf16_f32 v129, v114, v115
    v_cvt_pk_bf16_f32 v130, v116, v117
    v_cvt_pk_bf16_f32 v131, v118, v119
    ds_write_b128 v6, v[128:131] offset:128
    ds_read_b128 v[132:135], v8
    ds_read_b128 v[136:139], v9
    ds_read_b128 v[140:143], v10
    s_waitcnt lgkmcnt(2)
    buffer_store_dwordx4 v[132:135], v199, s[28:31], s81 offen offset:0 sc1
    s_waitcnt lgkmcnt(1)
    buffer_store_dwordx4 v[136:139], v200, s[28:31], s81 offen offset:1024 sc1
    s_waitcnt lgkmcnt(0)
    buffer_store_dwordx4 v[140:143], v201, s[28:31], s81 offen offset:2048 sc1
    s_waitcnt vmcnt(13)
    ds_read_b128 v[24:27], v4 offset:3072
    ds_read_b128 v[28:31], v4 offset:3136
    ds_read_b128 v[32:35], v4 offset:3200
    s_add_u32 m0, s33, 9216
    s_add_u32 s43, s82, 98304
    buffer_load_dwordx4 v202, s[16:19], s43 offen offset:0 nt lds
    buffer_load_dwordx4 v208, s[16:19], s43 offen offset:1024 nt lds
    buffer_load_dwordx4 v209, s[16:19], s43 offen offset:2048 nt lds
    s_waitcnt lgkmcnt(0)
    v_mfma_f32_16x16x32_bf16 v[96:99], a[0:3], v[24:27], v[72:75]
    v_mfma_f32_16x16x32_bf16 v[96:99], a[4:7], v[28:31], v[96:99]
    v_mfma_f32_16x16x32_bf16 v[96:99], a[8:11], v[32:35], v[96:99]
    v_mfma_f32_16x16x32_bf16 v[100:103], a[12:15], v[24:27], v[76:79]
    v_mfma_f32_16x16x32_bf16 v[100:103], a[16:19], v[28:31], v[100:103]
    v_mfma_f32_16x16x32_bf16 v[100:103], a[20:23], v[32:35], v[100:103]
    v_mfma_f32_16x16x32_bf16 v[104:107], a[24:27], v[24:27], v[80:83]
    v_mfma_f32_16x16x32_bf16 v[104:107], a[28:31], v[28:31], v[104:107]
    v_mfma_f32_16x16x32_bf16 v[104:107], a[32:35], v[32:35], v[104:107]
    v_mfma_f32_16x16x32_bf16 v[108:111], a[36:39], v[24:27], v[84:87]
    v_mfma_f32_16x16x32_bf16 v[108:111], a[40:43], v[28:31], v[108:111]
    v_mfma_f32_16x16x32_bf16 v[108:111], a[44:47], v[32:35], v[108:111]
    v_mfma_f32_16x16x32_bf16 v[112:115], a[48:51], v[24:27], v[88:91]
    v_cvt_pk_bf16_f32 v120, v96, v97
    v_mfma_f32_16x16x32_bf16 v[112:115], a[52:55], v[28:31], v[112:115]
    v_cvt_pk_bf16_f32 v121, v98, v99
    v_mfma_f32_16x16x32_bf16 v[112:115], a[56:59], v[32:35], v[112:115]
    v_cvt_pk_bf16_f32 v122, v100, v101
    v_mfma_f32_16x16x32_bf16 v[116:119], a[60:63], v[24:27], v[92:95]
    v_cvt_pk_bf16_f32 v123, v102, v103
    v_mfma_f32_16x16x32_bf16 v[116:119], a[64:67], v[28:31], v[116:119]
    ds_write_b128 v6, v[120:123] offset:0
    v_mfma_f32_16x16x32_bf16 v[116:119], a[68:71], v[32:35], v[116:119]
    v_cvt_pk_bf16_f32 v124, v104, v105
    v_cvt_pk_bf16_f32 v125, v106, v107
    v_cvt_pk_bf16_f32 v126, v108, v109
    v_cvt_pk_bf16_f32 v127, v110, v111
    ds_write_b128 v6, v[124:127] offset:64
    s_add_u32 s32, s81, 98304
    v_cvt_pk_bf16_f32 v128, v112, v113
    v_cvt_pk_bf16_f32 v129, v114, v115
    v_cvt_pk_bf16_f32 v130, v116, v117
    v_cvt_pk_bf16_f32 v131, v118, v119
    ds_write_b128 v6, v[128:131] offset:128
    ds_read_b128 v[132:135], v8
    ds_read_b128 v[136:139], v9
    ds_read_b128 v[140:143], v10
    s_waitcnt lgkmcnt(2)
    buffer_store_dwordx4 v[132:135], v199, s[28:31], s32 offen offset:0 sc1
    s_waitcnt lgkmcnt(1)
    buffer_store_dwordx4 v[136:139], v200, s[28:31], s32 offen offset:1024 sc1
    s_waitcnt lgkmcnt(0)
    buffer_store_dwordx4 v[140:143], v201, s[28:31], s32 offen offset:2048 sc1
    s_barrier
    s_waitcnt vmcnt(12)
    ds_read_b128 v[36:39], v5 offset:18432
    ds_read_b128 v[40:43], v5 offset:18496
    ds_read_b128 v[44:47], v5 offset:18560
    ds_read_b128 v[24:27], v4 offset:6144
    ds_read_b128 v[28:31], v4 offset:6208
    ds_read_b128 v[32:35], v4 offset:6272
    s_bitcmp1_b32 s38, 7
    s_cselect_b64 vcc, -1, 0
    v_cndmask_b32 v205, v186, v191, vcc
    v_cndmask_b32 v206, v187, v192, vcc
    v_cndmask_b32 v207, v188, v193, vcc
    v_xor_b32 v208, v7, v206
    v_xor_b32 v209, 32, v207
    s_add_u32 m0, s33, 12288
    s_nop 0
    buffer_load_dwordx4 v205, s[16:19], s83 offen offset:0 nt lds
    buffer_load_dwordx4 v208, s[16:19], s83 offen offset:1024 nt lds
    buffer_load_dwordx4 v209, s[16:19], s83 offen offset:2048 nt lds
    s_waitcnt lgkmcnt(3)
    v_mfma_f32_16x16x32_bf16 v[48:51], a[72:75], v[36:39], 0
    v_mfma_f32_16x16x32_bf16 v[48:51], a[76:79], v[40:43], v[48:51]
    v_mfma_f32_16x16x32_bf16 v[48:51], a[80:83], v[44:47], v[48:51]
    v_mfma_f32_16x16x32_bf16 v[52:55], a[84:87], v[36:39], 0
    v_mfma_f32_16x16x32_bf16 v[52:55], a[88:91], v[40:43], v[52:55]
    v_mfma_f32_16x16x32_bf16 v[52:55], a[92:95], v[44:47], v[52:55]
    v_mfma_f32_16x16x32_bf16 v[56:59], a[96:99], v[36:39], 0
    v_mfma_f32_16x16x32_bf16 v[56:59], a[100:103], v[40:43], v[56:59]
    v_mfma_f32_16x16x32_bf16 v[56:59], a[104:107], v[44:47], v[56:59]
    v_mfma_f32_16x16x32_bf16 v[60:63], a[108:111], v[36:39], 0
    v_mfma_f32_16x16x32_bf16 v[60:63], a[112:115], v[40:43], v[60:63]
    v_mfma_f32_16x16x32_bf16 v[60:63], a[116:119], v[44:47], v[60:63]
    v_mov_b32_dpp v72, v48 quad_perm:[0,0,1,1] row_mask:0xf bank_mask:0xf
    v_mov_b32_dpp v73, v49 quad_perm:[0,0,1,1] row_mask:0xf bank_mask:0xf
    v_mfma_f32_16x16x32_bf16 v[64:67], a[120:123], v[36:39], 0
    v_mov_b32_dpp v74, v50 quad_perm:[0,0,1,1] row_mask:0xf bank_mask:0xf
    v_mov_b32_dpp v75, v51 quad_perm:[0,0,1,1] row_mask:0xf bank_mask:0xf
    v_mfma_f32_16x16x32_bf16 v[64:67], a[124:127], v[40:43], v[64:67]
    v_mov_b32_dpp v76, v52 quad_perm:[0,0,1,1] row_mask:0xf bank_mask:0xf
    v_mov_b32_dpp v77, v53 quad_perm:[0,0,1,1] row_mask:0xf bank_mask:0xf
    v_mfma_f32_16x16x32_bf16 v[64:67], a[128:131], v[44:47], v[64:67]
    v_mov_b32_dpp v78, v54 quad_perm:[0,0,1,1] row_mask:0xf bank_mask:0xf
    v_mov_b32_dpp v79, v55 quad_perm:[0,0,1,1] row_mask:0xf bank_mask:0xf
    v_mfma_f32_16x16x32_bf16 v[68:71], a[132:135], v[36:39], 0
    v_mov_b32_dpp v80, v56 quad_perm:[0,0,1,1] row_mask:0xf bank_mask:0xf
    v_mov_b32_dpp v81, v57 quad_perm:[0,0,1,1] row_mask:0xf bank_mask:0xf
    v_mfma_f32_16x16x32_bf16 v[68:71], a[136:139], v[40:43], v[68:71]
    v_mov_b32_dpp v82, v58 quad_perm:[0,0,1,1] row_mask:0xf bank_mask:0xf
    v_mov_b32_dpp v83, v59 quad_perm:[0,0,1,1] row_mask:0xf bank_mask:0xf
    v_mfma_f32_16x16x32_bf16 v[68:71], a[140:143], v[44:47], v[68:71]
    v_mov_b32_dpp v84, v60 quad_perm:[0,0,1,1] row_mask:0xf bank_mask:0xf
    v_mov_b32_dpp v85, v61 quad_perm:[0,0,1,1] row_mask:0xf bank_mask:0xf
    v_mov_b32_dpp v86, v62 quad_perm:[0,0,1,1] row_mask:0xf bank_mask:0xf
    v_mov_b32_dpp v87, v63 quad_perm:[0,0,1,1] row_mask:0xf bank_mask:0xf
    v_mov_b32_dpp v88, v64 quad_perm:[0,0,1,1] row_mask:0xf bank_mask:0xf
    v_mov_b32_dpp v89, v65 quad_perm:[0,0,1,1] row_mask:0xf bank_mask:0xf
    v_mov_b32_dpp v90, v66 quad_perm:[0,0,1,1] row_mask:0xf bank_mask:0xf
    v_mov_b32_dpp v91, v67 quad_perm:[0,0,1,1] row_mask:0xf bank_mask:0xf
    v_mov_b32_dpp v92, v68 quad_perm:[0,0,1,1] row_mask:0xf bank_mask:0xf
    v_mov_b32_dpp v93, v69 quad_perm:[0,0,1,1] row_mask:0xf bank_mask:0xf
    v_mov_b32_dpp v94, v70 quad_perm:[0,0,1,1] row_mask:0xf bank_mask:0xf
    v_mov_b32_dpp v95, v71 quad_perm:[0,0,1,1] row_mask:0xf bank_mask:0xf
    s_waitcnt lgkmcnt(0)
    v_mfma_f32_16x16x32_bf16 v[96:99], a[0:3], v[24:27], v[72:75]
    v_mfma_f32_16x16x32_bf16 v[96:99], a[4:7], v[28:31], v[96:99]
    v_mfma_f32_16x16x32_bf16 v[96:99], a[8:11], v[32:35], v[96:99]
    v_mfma_f32_16x16x32_bf16 v[100:103], a[12:15], v[24:27], v[76:79]
    v_mfma_f32_16x16x32_bf16 v[100:103], a[16:19], v[28:31], v[100:103]
    v_mfma_f32_16x16x32_bf16 v[100:103], a[20:23], v[32:35], v[100:103]
    v_mfma_f32_16x16x32_bf16 v[104:107], a[24:27], v[24:27], v[80:83]
    v_mfma_f32_16x16x32_bf16 v[104:107], a[28:31], v[28:31], v[104:107]
    v_mfma_f32_16x16x32_bf16 v[104:107], a[32:35], v[32:35], v[104:107]
    v_mfma_f32_16x16x32_bf16 v[108:111], a[36:39], v[24:27], v[84:87]
    v_mfma_f32_16x16x32_bf16 v[108:111], a[40:43], v[28:31], v[108:111]
    v_mfma_f32_16x16x32_bf16 v[108:111], a[44:47], v[32:35], v[108:111]
    v_mfma_f32_16x16x32_bf16 v[112:115], a[48:51], v[24:27], v[88:91]
    v_cvt_pk_bf16_f32 v120, v96, v97
    v_mfma_f32_16x16x32_bf16 v[112:115], a[52:55], v[28:31], v[112:115]
    v_cvt_pk_bf16_f32 v121, v98, v99
    v_mfma_f32_16x16x32_bf16 v[112:115], a[56:59], v[32:35], v[112:115]
    v_cvt_pk_bf16_f32 v122, v100, v101
    v_mfma_f32_16x16x32_bf16 v[116:119], a[60:63], v[24:27], v[92:95]
    v_cvt_pk_bf16_f32 v123, v102, v103
    v_mfma_f32_16x16x32_bf16 v[116:119], a[64:67], v[28:31], v[116:119]
    ds_write_b128 v6, v[120:123] offset:0
    v_mfma_f32_16x16x32_bf16 v[116:119], a[68:71], v[32:35], v[116:119]
    v_cvt_pk_bf16_f32 v124, v104, v105
    v_cvt_pk_bf16_f32 v125, v106, v107
    v_cvt_pk_bf16_f32 v126, v108, v109
    v_cvt_pk_bf16_f32 v127, v110, v111
    ds_write_b128 v6, v[124:127] offset:64
    s_nop 0
    v_cvt_pk_bf16_f32 v128, v112, v113
    v_cvt_pk_bf16_f32 v129, v114, v115
    v_cvt_pk_bf16_f32 v130, v116, v117
    v_cvt_pk_bf16_f32 v131, v118, v119
    ds_write_b128 v6, v[128:131] offset:128
    ds_read_b128 v[132:135], v8
    ds_read_b128 v[136:139], v9
    ds_read_b128 v[140:143], v10
    s_waitcnt lgkmcnt(2)
    buffer_store_dwordx4 v[132:135], v202, s[28:31], s82 offen offset:0 sc1
    s_waitcnt lgkmcnt(1)
    buffer_store_dwordx4 v[136:139], v203, s[28:31], s82 offen offset:1024 sc1
    s_waitcnt lgkmcnt(0)
    buffer_store_dwordx4 v[140:143], v204, s[28:31], s82 offen offset:2048 sc1
    s_waitcnt vmcnt(9)
    ds_read_b128 v[24:27], v4 offset:9216
    ds_read_b128 v[28:31], v4 offset:9280
    ds_read_b128 v[32:35], v4 offset:9344
    s_waitcnt lgkmcnt(0)
    v_mfma_f32_16x16x32_bf16 v[96:99], a[0:3], v[24:27], v[72:75]
    v_mfma_f32_16x16x32_bf16 v[96:99], a[4:7], v[28:31], v[96:99]
    v_mfma_f32_16x16x32_bf16 v[96:99], a[8:11], v[32:35], v[96:99]
    v_mfma_f32_16x16x32_bf16 v[100:103], a[12:15], v[24:27], v[76:79]
    v_mfma_f32_16x16x32_bf16 v[100:103], a[16:19], v[28:31], v[100:103]
    v_mfma_f32_16x16x32_bf16 v[100:103], a[20:23], v[32:35], v[100:103]
    v_mfma_f32_16x16x32_bf16 v[104:107], a[24:27], v[24:27], v[80:83]
    v_mfma_f32_16x16x32_bf16 v[104:107], a[28:31], v[28:31], v[104:107]
    v_mfma_f32_16x16x32_bf16 v[104:107], a[32:35], v[32:35], v[104:107]
    v_mfma_f32_16x16x32_bf16 v[108:111], a[36:39], v[24:27], v[84:87]
    v_mfma_f32_16x16x32_bf16 v[108:111], a[40:43], v[28:31], v[108:111]
    v_mfma_f32_16x16x32_bf16 v[108:111], a[44:47], v[32:35], v[108:111]
    v_mfma_f32_16x16x32_bf16 v[112:115], a[48:51], v[24:27], v[88:91]
    v_cvt_pk_bf16_f32 v120, v96, v97
    v_mfma_f32_16x16x32_bf16 v[112:115], a[52:55], v[28:31], v[112:115]
    v_cvt_pk_bf16_f32 v121, v98, v99
    v_mfma_f32_16x16x32_bf16 v[112:115], a[56:59], v[32:35], v[112:115]
    v_cvt_pk_bf16_f32 v122, v100, v101
    v_mfma_f32_16x16x32_bf16 v[116:119], a[60:63], v[24:27], v[92:95]
    v_cvt_pk_bf16_f32 v123, v102, v103
    v_mfma_f32_16x16x32_bf16 v[116:119], a[64:67], v[28:31], v[116:119]
    ds_write_b128 v6, v[120:123] offset:0
    v_mfma_f32_16x16x32_bf16 v[116:119], a[68:71], v[32:35], v[116:119]
    v_cvt_pk_bf16_f32 v124, v104, v105
    v_cvt_pk_bf16_f32 v125, v106, v107
    v_cvt_pk_bf16_f32 v126, v108, v109
    v_cvt_pk_bf16_f32 v127, v110, v111
    ds_write_b128 v6, v[124:127] offset:64
    s_add_u32 s32, s82, 98304
    v_cvt_pk_bf16_f32 v128, v112, v113
    v_cvt_pk_bf16_f32 v129, v114, v115
    v_cvt_pk_bf16_f32 v130, v116, v117
    v_cvt_pk_bf16_f32 v131, v118, v119
    ds_write_b128 v6, v[128:131] offset:128
    ds_read_b128 v[132:135], v8
    ds_read_b128 v[136:139], v9
    ds_read_b128 v[140:143], v10
    s_waitcnt lgkmcnt(2)
    buffer_store_dwordx4 v[132:135], v202, s[28:31], s32 offen offset:0 sc1
    s_waitcnt lgkmcnt(1)
    buffer_store_dwordx4 v[136:139], v203, s[28:31], s32 offen offset:1024 sc1
    s_waitcnt lgkmcnt(0)
    buffer_store_dwordx4 v[140:143], v204, s[28:31], s32 offen offset:2048 sc1
    s_waitcnt vmcnt(6)
    ds_read_b128 v[24:27], v4 offset:12288
    ds_read_b128 v[28:31], v4 offset:12352
    ds_read_b128 v[32:35], v4 offset:12416
    s_add_u32 m0, s33, 0
    s_add_u32 s43, s83, 98304
    buffer_load_dwordx4 v205, s[16:19], s43 offen offset:0 nt lds
    buffer_load_dwordx4 v208, s[16:19], s43 offen offset:1024 nt lds
    buffer_load_dwordx4 v209, s[16:19], s43 offen offset:2048 nt lds
    v_mov_b32_dpp v72, v48 quad_perm:[2,2,3,3] row_mask:0xf bank_mask:0xf
    v_mov_b32_dpp v73, v49 quad_perm:[2,2,3,3] row_mask:0xf bank_mask:0xf
    v_mov_b32_dpp v74, v50 quad_perm:[2,2,3,3] row_mask:0xf bank_mask:0xf
    v_mov_b32_dpp v75, v51 quad_perm:[2,2,3,3] row_mask:0xf bank_mask:0xf
    v_mov_b32_dpp v76, v52 quad_perm:[2,2,3,3] row_mask:0xf bank_mask:0xf
    v_mov_b32_dpp v77, v53 quad_perm:[2,2,3,3] row_mask:0xf bank_mask:0xf
    v_mov_b32_dpp v78, v54 quad_perm:[2,2,3,3] row_mask:0xf bank_mask:0xf
    v_mov_b32_dpp v79, v55 quad_perm:[2,2,3,3] row_mask:0xf bank_mask:0xf
    v_mov_b32_dpp v80, v56 quad_perm:[2,2,3,3] row_mask:0xf bank_mask:0xf
    v_mov_b32_dpp v81, v57 quad_perm:[2,2,3,3] row_mask:0xf bank_mask:0xf
    v_mov_b32_dpp v82, v58 quad_perm:[2,2,3,3] row_mask:0xf bank_mask:0xf
    v_mov_b32_dpp v83, v59 quad_perm:[2,2,3,3] row_mask:0xf bank_mask:0xf
    v_mov_b32_dpp v84, v60 quad_perm:[2,2,3,3] row_mask:0xf bank_mask:0xf
    v_mov_b32_dpp v85, v61 quad_perm:[2,2,3,3] row_mask:0xf bank_mask:0xf
    v_mov_b32_dpp v86, v62 quad_perm:[2,2,3,3] row_mask:0xf bank_mask:0xf
    v_mov_b32_dpp v87, v63 quad_perm:[2,2,3,3] row_mask:0xf bank_mask:0xf
    v_mov_b32_dpp v88, v64 quad_perm:[2,2,3,3] row_mask:0xf bank_mask:0xf
    v_mov_b32_dpp v89, v65 quad_perm:[2,2,3,3] row_mask:0xf bank_mask:0xf
    v_mov_b32_dpp v90, v66 quad_perm:[2,2,3,3] row_mask:0xf bank_mask:0xf
    v_mov_b32_dpp v91, v67 quad_perm:[2,2,3,3] row_mask:0xf bank_mask:0xf
    v_mov_b32_dpp v92, v68 quad_perm:[2,2,3,3] row_mask:0xf bank_mask:0xf
    v_mov_b32_dpp v93, v69 quad_perm:[2,2,3,3] row_mask:0xf bank_mask:0xf
    v_mov_b32_dpp v94, v70 quad_perm:[2,2,3,3] row_mask:0xf bank_mask:0xf
    v_mov_b32_dpp v95, v71 quad_perm:[2,2,3,3] row_mask:0xf bank_mask:0xf
    s_waitcnt lgkmcnt(0)
    v_mfma_f32_16x16x32_bf16 v[96:99], a[0:3], v[24:27], v[72:75]
    v_mfma_f32_16x16x32_bf16 v[96:99], a[4:7], v[28:31], v[96:99]
    v_mfma_f32_16x16x32_bf16 v[96:99], a[8:11], v[32:35], v[96:99]
    v_mfma_f32_16x16x32_bf16 v[100:103], a[12:15], v[24:27], v[76:79]
    v_mfma_f32_16x16x32_bf16 v[100:103], a[16:19], v[28:31], v[100:103]
    v_mfma_f32_16x16x32_bf16 v[100:103], a[20:23], v[32:35], v[100:103]
    v_mfma_f32_16x16x32_bf16 v[104:107], a[24:27], v[24:27], v[80:83]
    v_mfma_f32_16x16x32_bf16 v[104:107], a[28:31], v[28:31], v[104:107]
    v_mfma_f32_16x16x32_bf16 v[104:107], a[32:35], v[32:35], v[104:107]
    v_mfma_f32_16x16x32_bf16 v[108:111], a[36:39], v[24:27], v[84:87]
    v_mfma_f32_16x16x32_bf16 v[108:111], a[40:43], v[28:31], v[108:111]
    v_mfma_f32_16x16x32_bf16 v[108:111], a[44:47], v[32:35], v[108:111]
    v_mfma_f32_16x16x32_bf16 v[112:115], a[48:51], v[24:27], v[88:91]
    v_cvt_pk_bf16_f32 v120, v96, v97
    v_mfma_f32_16x16x32_bf16 v[112:115], a[52:55], v[28:31], v[112:115]
    v_cvt_pk_bf16_f32 v121, v98, v99
    v_mfma_f32_16x16x32_bf16 v[112:115], a[56:59], v[32:35], v[112:115]
    v_cvt_pk_bf16_f32 v122, v100, v101
    v_mfma_f32_16x16x32_bf16 v[116:119], a[60:63], v[24:27], v[92:95]
    v_cvt_pk_bf16_f32 v123, v102, v103
    v_mfma_f32_16x16x32_bf16 v[116:119], a[64:67], v[28:31], v[116:119]
    ds_write_b128 v6, v[120:123] offset:0
    v_mfma_f32_16x16x32_bf16 v[116:119], a[68:71], v[32:35], v[116:119]
    v_cvt_pk_bf16_f32 v124, v104, v105
    v_cvt_pk_bf16_f32 v125, v106, v107
    v_cvt_pk_bf16_f32 v126, v108, v109
    v_cvt_pk_bf16_f32 v127, v110, v111
    ds_write_b128 v6, v[124:127] offset:64
    s_nop 0
    v_cvt_pk_bf16_f32 v128, v112, v113
    v_cvt_pk_bf16_f32 v129, v114, v115
    v_cvt_pk_bf16_f32 v130, v116, v117
    v_cvt_pk_bf16_f32 v131, v118, v119
    ds_write_b128 v6, v[128:131] offset:128
    ds_read_b128 v[132:135], v8
    ds_read_b128 v[136:139], v9
    ds_read_b128 v[140:143], v10
    s_waitcnt lgkmcnt(2)
    buffer_store_dwordx4 v[132:135], v205, s[28:31], s83 offen offset:0 sc1
    s_waitcnt lgkmcnt(1)
    buffer_store_dwordx4 v[136:139], v206, s[28:31], s83 offen offset:1024 sc1
    s_waitcnt lgkmcnt(0)
    buffer_store_dwordx4 v[140:143], v207, s[28:31], s83 offen offset:2048 sc1
    s_waitcnt vmcnt(3)
    ds_read_b128 v[24:27], v4 offset:0
    ds_read_b128 v[28:31], v4 offset:64
    ds_read_b128 v[32:35], v4 offset:128
    s_waitcnt lgkmcnt(0)
    v_mfma_f32_16x16x32_bf16 v[96:99], a[0:3], v[24:27], v[72:75]
    v_mfma_f32_16x16x32_bf16 v[96:99], a[4:7], v[28:31], v[96:99]
    v_mfma_f32_16x16x32_bf16 v[96:99], a[8:11], v[32:35], v[96:99]
    v_mfma_f32_16x16x32_bf16 v[100:103], a[12:15], v[24:27], v[76:79]
    v_mfma_f32_16x16x32_bf16 v[100:103], a[16:19], v[28:31], v[100:103]
    v_mfma_f32_16x16x32_bf16 v[100:103], a[20:23], v[32:35], v[100:103]
    v_mfma_f32_16x16x32_bf16 v[104:107], a[24:27], v[24:27], v[80:83]
    v_mfma_f32_16x16x32_bf16 v[104:107], a[28:31], v[28:31], v[104:107]
    v_mfma_f32_16x16x32_bf16 v[104:107], a[32:35], v[32:35], v[104:107]
    v_mfma_f32_16x16x32_bf16 v[108:111], a[36:39], v[24:27], v[84:87]
    v_mfma_f32_16x16x32_bf16 v[108:111], a[40:43], v[28:31], v[108:111]
    v_mfma_f32_16x16x32_bf16 v[108:111], a[44:47], v[32:35], v[108:111]
    v_mfma_f32_16x16x32_bf16 v[112:115], a[48:51], v[24:27], v[88:91]
    v_cvt_pk_bf16_f32 v120, v96, v97
    v_mfma_f32_16x16x32_bf16 v[112:115], a[52:55], v[28:31], v[112:115]
    v_cvt_pk_bf16_f32 v121, v98, v99
    v_mfma_f32_16x16x32_bf16 v[112:115], a[56:59], v[32:35], v[112:115]
    v_cvt_pk_bf16_f32 v122, v100, v101
    v_mfma_f32_16x16x32_bf16 v[116:119], a[60:63], v[24:27], v[92:95]
    v_cvt_pk_bf16_f32 v123, v102, v103
    v_mfma_f32_16x16x32_bf16 v[116:119], a[64:67], v[28:31], v[116:119]
    ds_write_b128 v6, v[120:123] offset:0
    v_mfma_f32_16x16x32_bf16 v[116:119], a[68:71], v[32:35], v[116:119]
    v_cvt_pk_bf16_f32 v124, v104, v105
    v_cvt_pk_bf16_f32 v125, v106, v107
    v_cvt_pk_bf16_f32 v126, v108, v109
    v_cvt_pk_bf16_f32 v127, v110, v111
    ds_write_b128 v6, v[124:127] offset:64
    s_add_u32 s32, s83, 98304
    v_cvt_pk_bf16_f32 v128, v112, v113
    v_cvt_pk_bf16_f32 v129, v114, v115
    v_cvt_pk_bf16_f32 v130, v116, v117
    v_cvt_pk_bf16_f32 v131, v118, v119
    ds_write_b128 v6, v[128:131] offset:128
    ds_read_b128 v[132:135], v8
    ds_read_b128 v[136:139], v9
    ds_read_b128 v[140:143], v10
    s_waitcnt lgkmcnt(2)
    buffer_store_dwordx4 v[132:135], v205, s[28:31], s32 offen offset:0
    s_waitcnt lgkmcnt(1)
    buffer_store_dwordx4 v[136:139], v206, s[28:31], s32 offen offset:1024
    s_waitcnt lgkmcnt(0)
    buffer_store_dwordx4 v[140:143], v207, s[28:31], s32 offen offset:2048
L_end:
    s_endpgm
L_tab_slow:
    s_add_u32 s69, s69, 1
    s_cmp_le_u32 s69, 32
    s_cbranch_scc1 L_tab_reload
    v_xor_b32 v16, s68, v16
    v_lshl_add_u32 v16, v16, 1, v16
    v_or_b32 v18, v16, v21
    v_mov_b32 v19, v21
    s_mov_b32 exec_lo, s3
    s_mov_b32 exec_hi, 0
    buffer_atomic_cmpswap v[18:19], v20, s[92:95], 0 offen sc1
    s_mov_b64 exec, -1
    s_waitcnt vmcnt(0)
L_tab_reload:
    buffer_load_dword v21, v20, s[92:95], 0 offen sc0 sc1
    s_waitcnt vmcnt(0)
    s_branch L_tab
.section .rodata,"a"
.p2align 6
.amdhsa_kernel standalone__detection_seg_fpn_lateral__vision_kernel
  .amdhsa_next_free_vgpr 364
  .amdhsa_next_free_sgpr 96
  .amdhsa_accum_offset 220
  .amdhsa_group_segment_fixed_size 0
  .amdhsa_float_denorm_mode_32 3
  .amdhsa_kernarg_size 56
  .amdhsa_user_sgpr_count 2
  .amdhsa_user_sgpr_kernarg_segment_ptr 1
  .amdhsa_system_sgpr_workgroup_id_x 1
.end_amdhsa_kernel
```
